```python
import torch

def _softmax(x, axis=-1):
    return torch.softmax(x, dim=axis)
def _gelu(x):
    return torch.nn.functional.gelu(x, approximate="tanh")
def _silu(x):
    return torch.nn.functional.silu(x)
def _sigmoid(x):
    return torch.sigmoid(x)
def _layernorm(x, axis=-1, eps=1e-5):
    m = x.mean(dim=axis, keepdim=True)
    v = x.var(dim=axis, keepdim=True, unbiased=False)
    return (x - m) / torch.sqrt(v + eps)
def _scatter_add(tgt, idx, src, axis=0):
    return tgt.clone().index_add_(axis, idx, src)
def _segment_sum(src, seg, n):
    out = torch.zeros((n,) + src.shape[1:], dtype=src.dtype)
    return out.index_add_(0, seg, src)
def _pad(x, pw):
    flat = tuple(v for pair in reversed(pw) for v in pair)
    return torch.nn.functional.pad(x, flat)

kernel_name = 'interleave_layers__ssm_conv_s4d__mixer_channel_mlp__prompt'

def setup_inputs():

    _w = (lambda a: (lambda t: t.to(torch.bfloat16) if t.is_floating_point() else t)(torch.as_tensor(a)))
    def _A_setup():
        Bsz, L, D, N = 1, 2048, 512, 128
        return {
            "u": _w((lambda *s: torch.randn(*s, dtype=torch.bfloat16) * 0.05)(Bsz, L, D)),
            "log_A_real": _w((lambda *s: torch.randn(*s, dtype=torch.bfloat16) * 3.2)(D, N) * 0.5),
            "A_imag": _w((lambda *s: torch.randn(*s, dtype=torch.bfloat16) * 0.05)(D, N) * 3.14),
            "C_real": _w((lambda *s: torch.randn(*s, dtype=torch.bfloat16) * 0.05)(D, N) / N ** 0.5),
            "C_imag": _w((lambda *s: torch.randn(*s, dtype=torch.bfloat16) * 0.05)(D, N) / N ** 0.5),
            "log_dt": _w((lambda *s: torch.randn(*s, dtype=torch.bfloat16) * 0.05)(D) * 0.5 - 4.0),
            "D_skip": _w((lambda *s: torch.randn(*s, dtype=torch.bfloat16) * 0.05)(D)),
        }
    _A_in = _A_setup()

    def _B_setup():
        B, S, D, F = 1, 2048, 512, 1792
        return {
            "x": _w((lambda *s: torch.randn(*s, dtype=torch.bfloat16) * 0.05)(B, S, D)),
            "w1": _w((lambda *s: torch.randn(*s, dtype=torch.bfloat16) * 1.6)(D, F) * (D ** -0.5)),
            "b1": _w((lambda *s: torch.randn(*s, dtype=torch.bfloat16) * 0.4)(F)),
            "w2": _w((lambda *s: torch.randn(*s, dtype=torch.bfloat16) * 0.1)(F, D) * (F ** -0.5)),
            "b2": _w((lambda *s: torch.randn(*s, dtype=torch.bfloat16) * 0.1)(D)),
        }
    _B_in = _B_setup()

    return {
        "A_u": _A_in["u"],
        "A_log_A_real": _A_in["log_A_real"],
        "A_A_imag": _A_in["A_imag"],
        "A_C_real": _A_in["C_real"],
        "A_C_imag": _A_in["C_imag"],
        "A_log_dt": _A_in["log_dt"],
        "A_D_skip": _A_in["D_skip"],
        "B_x": _B_in["x"],
        "B_w1": _B_in["w1"],
        "B_b1": _B_in["b1"],
        "B_w2": _B_in["w2"],
        "B_b2": _B_in["b2"],
    }

def reference(A_u, A_log_A_real, A_A_imag, A_C_real, A_C_imag, A_log_dt, A_D_skip, B_x, B_w1, B_b1, B_w2, B_b2):
    def _A_ref(u, log_A_real, A_imag, C_real, C_imag, log_dt, D_skip):
        L = u.shape[1]
        dt = torch.exp(log_dt)
        A = -torch.exp(log_A_real) + 1j * A_imag
        C = (C_real + 1j * C_imag) * dt[:, None]
        pos = (lambda x, dt: x.to(dt))(torch.arange(L), log_dt.dtype)
        P = torch.exp((A * dt[:, None])[:, :, None] * pos[None, None, :])
        K = 2.0 * torch.einsum("dn,dnl->dl", C, P).real
        L2 = 2 * L
        u_t = (lambda x, *d: x.permute(*d))(u, 0, 2, 1)
        Kf = (lambda x, *a, **k: torch.fft.rfft(x.float(), *a, **k))(K, L2)
        Uf = (lambda x, *a, **k: torch.fft.rfft(x.float(), *a, **k))(u_t, L2)
        y = (lambda x, *a, **k: torch.fft.irfft(x, *a, **k).to(torch.bfloat16))(Uf * Kf[None, :, :], L2)[:, :, :L]
        y = (lambda x, *d: x.permute(*d))(y, 0, 2, 1)
        return y + u * D_skip[None, None, :]

    def _B_ref(x, w1, b1, w2, b2):
        y = _layernorm(x, axis=-1)
        h = _gelu(torch.einsum("bsd,df->bsf", y, w1) + b1)
        return torch.einsum("bsf,fd->bsd", h, w2) + b2

    x = A_u
    x = x + _A_ref(_layernorm(x, axis=-1), A_log_A_real, A_A_imag, A_C_real, A_C_imag, A_log_dt, A_D_skip)
    x = x + _B_ref(_layernorm(x, axis=-1), B_w1, B_b1, B_w2, B_b2)
    x = x + _A_ref(_layernorm(x, axis=-1), A_log_A_real, A_A_imag, A_C_real, A_C_imag, A_log_dt, A_D_skip)
    x = x + _B_ref(_layernorm(x, axis=-1), B_w1, B_b1, B_w2, B_b2)
    return x
```

```asm
; @launch kernel=prep_kernel grid=(761,1,1) block=(256,1,1) lds=32768
; @launch kernel=cm1_kernel grid=(256,1,1) block=(512,1,1) lds=139264
; @launch kernel=cm2_kernel grid=(256,1,1) block=(512,1,1) lds=139264
.amdgcn_target "amdgcn-amd-amdhsa--gfx950"
.text
.globl prep_kernel
.p2align 8
.type prep_kernel,@function
prep_kernel:
    s_cmp_ge_u32 s2, 761
    s_cbranch_scc1 Lprep_end
    s_load_dwordx2 s[4:5], s[0:1], 112
    v_mov_b32 v127, v0
    v_and_b32 v1, 63, v0
    v_lshrrev_b32 v2, 6, v0
    s_nop 0
    v_readfirstlane_b32 s3, v2
    s_cmp_lt_u32 s2, 512
    s_cbranch_scc1 Lprep_kgen
    s_cmp_lt_u32 s2, 576
    s_cbranch_scc1 Lprep_xt
    s_cmp_lt_u32 s2, 640
    s_cbranch_scc1 Lprep_st
    s_cmp_lt_u32 s2, 696
    s_cbranch_scc1 Lprep_w1
    s_cmp_lt_u32 s2, 752
    s_cbranch_scc1 Lprep_w2
    s_waitcnt lgkmcnt(0)
    s_cmp_lt_u32 s2, 753
    s_cbranch_scc1 Lprep_z
    s_branch Lprep_pf
Lprep_kgen:
    s_load_dwordx8 s[12:19], s[0:1], 8
    s_load_dwordx2 s[20:21], s[0:1], 40
    s_getpc_b64 s[30:31]
Lkg_pc:
    s_add_u32 s30, s30, Lkg_tab-Lkg_pc
    s_addc_u32 s31, s31, 0
    v_lshlrev_b32 v40, 5, v1
    v_lshlrev_b32 v41, 4, v0
    global_load_dwordx4 v[32:35], v40, s[30:31]
    global_load_dwordx4 v[44:47], v40, s[30:31] offset:16
    global_load_dwordx4 v[52:55], v41, s[30:31] offset:2048
    v_and_b32 v3, 31, v0
    v_lshl_add_u32 v4, v2, 5, v3
    s_lshl_b32 s22, s2, 8
    v_lshl_add_u32 v4, v4, 1, s22
    s_lshl_b32 s23, s2, 1
    v_mov_b32 v9, s23
    v_and_b32 v42, 0xff, v41
    v_add_u32 v42, 4096+2048, v42
    global_load_dwordx4 v[60:63], v42, s[30:31]
    s_waitcnt lgkmcnt(0)
    global_load_ushort v5, v4, s[12:13]
    global_load_ushort v6, v4, s[14:15]
    global_load_ushort v7, v4, s[16:17]
    global_load_ushort v8, v4, s[18:19]
    global_load_ushort v9, v9, s[20:21]
    s_mov_b32 s8, s4
    s_mov_b32 s9, s5
    s_mov_b32 s10, 0x10000000
    s_mov_b32 s11, 0x00020000
    v_lshlrev_b32 v36, 10, v2
    v_lshrrev_b32 v31, 4, v1
    v_lshl_add_u32 v37, v31, 6, v36
    v_lshl_add_u32 v36, v3, 5, v36
    s_mul_i32 s24, s3, 3072
    s_mov_b32 s25, 0x3e22f983
    s_mov_b32 s34, 0x41600000
    s_mov_b32 s35, 0
    s_waitcnt vmcnt(0)
    v_lshlrev_b32 v5, 16, v5
    v_lshlrev_b32 v9, 16, v9
    v_mul_f32 v9, 0x3fb8aa3b, v9
    v_mul_f32 v5, 0x3fb8aa3b, v5
    v_exp_f32 v9, v9
    v_exp_f32 v5, v5
    v_lshlrev_b32 v6, 16, v6
    v_lshlrev_b32 v7, 16, v7
    v_lshlrev_b32 v8, 16, v8
    v_cvt_pk_bf16_f32 v9, v9, v5
    v_and_b32 v5, 0xffff0000, v9
    v_lshlrev_b32 v9, 16, v9
    v_mul_f32 v20, v7, v9
    v_mul_f32 v21, v8, v9
    v_max_f32 v12, abs(v20), abs(v21)
    v_mul_f32 v5, v5, v9
    v_mul_f32 v6, v6, v9
    v_max_f32_dpp v12, v12, v12 row_shr:1 row_mask:0xf bank_mask:0xf
    v_mul_f32 v16, 0xbfb8aa3b, v5
    v_mul_f32 v11, s25, v6
    v_max_f32_dpp v12, v12, v12 row_shr:2 row_mask:0xf bank_mask:0xf
    v_fma_f32 v18, v6, s25, -v11
    v_and_b32 v17, 0xffffff00, v11
    v_max_f32_dpp v12, v12, v12 row_shr:4 row_mask:0xf bank_mask:0xf
    v_fmac_f32 v18, 0x31dc9c88, v6
    v_sub_f32 v14, v11, v17
    v_max_f32_dpp v12, v12, v12 row_shr:8 row_mask:0xf bank_mask:0xf
    v_add_f32 v18, v18, v14
    v_add_u32 v44, s24, v44
    v_readlane_b32 s26, v12, 15
    v_readlane_b32 s27, v12, 31
    v_add_u32 v45, s24, v45
    v_add_u32 v46, s24, v46
    v_add_u32 v47, s24, v47
    s_max_u32 s26, s26, s27
    s_lshr_b32 s26, s26, 23
    s_sub_u32 s26, 267, s26
    s_min_u32 s26, s26, 239
    s_sub_u32 s27, 241, s26
    s_lshl_b32 s26, s26, 23
    s_lshl_b32 s28, s27, 23
    s_mov_b32 s29, s28
    v_mul_f32 v20, s26, v20
    v_mul_f32 v21, s26, v21
    ds_write_b128 v36, v[16:19]
    ds_write_b64 v36, v[20:21] offset:16
    s_waitcnt lgkmcnt(0)
    v_pk_mul_f32 v[100:101], v[32:33], 0 op_sel_hi:[1,0]
    v_pk_mul_f32 v[102:103], v[32:33], 0 op_sel_hi:[1,0]
    v_pk_mul_f32 v[104:105], v[32:33], 0 op_sel_hi:[1,0]
    v_pk_mul_f32 v[106:107], v[32:33], 0 op_sel_hi:[1,0]
    v_pk_mul_f32 v[108:109], v[32:33], 0 op_sel_hi:[1,0]
    v_pk_mul_f32 v[110:111], v[32:33], 0 op_sel_hi:[1,0]
    s_mov_b32 s36, 0
Lkg_loop:
    ds_read_b128 v[64:67], v37 offset:0
    ds_read_b64 v[68:69], v37 offset:16
    ds_read_b128 v[70:73], v37 offset:32
    ds_read_b64 v[74:75], v37 offset:48
    v_add_u32 v37, 256, v37
    s_waitcnt lgkmcnt(2)
    v_pk_fma_f32 v[88:89], v[64:65], v[32:33], 0 op_sel:[0,0,0] op_sel_hi:[1,0,0]
    v_pk_fma_f32 v[90:91], v[64:65], v[32:33], s[34:35] op_sel:[0,1,0] op_sel_hi:[1,1,1]
    v_pk_fma_f32 v[92:93], v[64:65], v[34:35], s[34:35] op_sel:[0,0,0] op_sel_hi:[1,0,1]
    v_pk_fma_f32 v[94:95], v[64:65], v[34:35], s[34:35] op_sel:[0,1,0] op_sel_hi:[1,1,1]
    v_fract_f32 v89, v89
    v_fract_f32 v91, v91
    v_fract_f32 v93, v93
    v_fract_f32 v95, v95
    v_exp_f32 v88, v88
    v_exp_f32 v90, v90
    v_exp_f32 v92, v92
    v_exp_f32 v94, v94
    v_fmac_f32 v89, v66, v32
    v_fmac_f32 v91, v66, v33
    v_fmac_f32 v93, v66, v34
    v_fmac_f32 v95, v66, v35
    v_cos_f32 v4, v89
    v_sin_f32 v5, v89
    v_cos_f32 v6, v91
    v_sin_f32 v7, v91
    v_cos_f32 v8, v93
    v_sin_f32 v9, v93
    v_cos_f32 v10, v95
    v_sin_f32 v11, v95
    v_pk_mul_f32 v[4:5], v[4:5], v[88:89] op_sel_hi:[1,0]
    v_pk_mul_f32 v[6:7], v[6:7], v[90:91] op_sel_hi:[1,0]
    v_pk_mul_f32 v[8:9], v[8:9], v[92:93] op_sel_hi:[1,0]
    v_pk_mul_f32 v[10:11], v[10:11], v[94:95] op_sel_hi:[1,0]
    v_pk_mul_f32 v[88:89], v[4:5], v[68:69] op_sel_hi:[1,0] neg_hi:[1,0]
    v_cvt_pk_f16_f32 v112, v6, v7
    v_pk_fma_f32 v[88:89], v[4:5], v[68:69], v[88:89] op_sel:[1,1,0] op_sel_hi:[0,1,1] neg_lo:[1,0,0] neg_hi:[1,0,0]
    v_cvt_pk_f16_f32 v114, v8, v9
    v_cvt_pk_f16_f32 v116, v10, v11
    v_cvt_pk_f16_f32 v24, v88, v89
    s_waitcnt lgkmcnt(0)
    v_pk_fma_f32 v[88:89], v[70:71], v[32:33], 0 op_sel:[0,0,0] op_sel_hi:[1,0,0]
    v_pk_fma_f32 v[90:91], v[70:71], v[32:33], s[34:35] op_sel:[0,1,0] op_sel_hi:[1,1,1]
    v_pk_fma_f32 v[92:93], v[70:71], v[34:35], s[34:35] op_sel:[0,0,0] op_sel_hi:[1,0,1]
    v_pk_fma_f32 v[94:95], v[70:71], v[34:35], s[34:35] op_sel:[0,1,0] op_sel_hi:[1,1,1]
    v_fract_f32 v89, v89
    v_fract_f32 v91, v91
    v_fract_f32 v93, v93
    v_fract_f32 v95, v95
    v_exp_f32 v88, v88
    v_exp_f32 v90, v90
    v_exp_f32 v92, v92
    v_exp_f32 v94, v94
    v_fmac_f32 v89, v72, v32
    v_fmac_f32 v91, v72, v33
    v_fmac_f32 v93, v72, v34
    v_fmac_f32 v95, v72, v35
    v_cos_f32 v4, v89
    v_sin_f32 v5, v89
    v_cos_f32 v6, v91
    v_sin_f32 v7, v91
    v_cos_f32 v8, v93
    v_sin_f32 v9, v93
    v_cos_f32 v10, v95
    v_sin_f32 v11, v95
    v_pk_mul_f32 v[4:5], v[4:5], v[88:89] op_sel_hi:[1,0]
    v_pk_mul_f32 v[6:7], v[6:7], v[90:91] op_sel_hi:[1,0]
    v_pk_mul_f32 v[8:9], v[8:9], v[92:93] op_sel_hi:[1,0]
    v_pk_mul_f32 v[10:11], v[10:11], v[94:95] op_sel_hi:[1,0]
    v_pk_mul_f32 v[88:89], v[4:5], v[74:75] op_sel_hi:[1,0] neg_hi:[1,0]
    v_cvt_pk_f16_f32 v113, v6, v7
    v_pk_fma_f32 v[88:89], v[4:5], v[74:75], v[88:89] op_sel:[1,1,0] op_sel_hi:[0,1,1] neg_lo:[1,0,0] neg_hi:[1,0,0]
    v_cvt_pk_f16_f32 v115, v8, v9
    v_cvt_pk_f16_f32 v117, v10, v11
    v_cvt_pk_f16_f32 v25, v88, v89
    s_add_u32 s36, s36, 1
    s_cmp_lt_u32 s36, 4
    v_mfma_f32_16x16x16_f16 v[100:103], v[112:113], v[24:25], v[100:103]
    v_mfma_f32_16x16x16_f16 v[104:107], v[114:115], v[24:25], v[104:107]
    v_mfma_f32_16x16x16_f16 v[108:111], v[116:117], v[24:25], v[108:111]
    s_cbranch_scc1 Lkg_loop
    v_lshrrev_b32 v65, 16, v52
    v_and_b32 v64, 0xffff, v52
    v_lshrrev_b32 v73, 16, v60
    v_and_b32 v72, 0xffff, v60
    v_lshrrev_b32 v67, 16, v53
    v_and_b32 v66, 0xffff, v53
    v_lshrrev_b32 v75, 16, v61
    v_and_b32 v74, 0xffff, v61
    v_lshrrev_b32 v69, 16, v54
    v_and_b32 v68, 0xffff, v54
    v_lshrrev_b32 v77, 16, v62
    v_and_b32 v76, 0xffff, v62
    v_lshrrev_b32 v71, 16, v55
    v_and_b32 v70, 0xffff, v55
    v_lshrrev_b32 v79, 16, v63
    v_and_b32 v78, 0xffff, v63
    v_pk_mul_f32 v[100:101], v[100:101], s[28:29]
    v_pk_mul_f32 v[102:103], v[102:103], s[28:29]
    v_pk_mul_f32 v[104:105], v[104:105], s[28:29]
    v_pk_mul_f32 v[106:107], v[106:107], s[28:29]
    v_pk_mul_f32 v[108:109], v[108:109], s[28:29]
    v_pk_mul_f32 v[110:111], v[110:111], s[28:29]
    v_lshlrev_b32 v40, 2, v0
    v_lshlrev_b32 v42, 1, v0
    v_mov_b32 v43, 0
    ds_write_b128 v44, v[100:103]
    ds_write_b64 v45, v[104:105]
    ds_write_b64 v46, v[106:107]
    ds_write_b32 v47, v108
    ds_write_b32 v47, v109 offset:64
    ds_write_b32 v47, v110 offset:128
    ds_write_b32 v47, v111 offset:192
    ds_write_b16 v43, v43 offset:17920
    s_waitcnt lgkmcnt(0)
    s_barrier
    ds_read_b32 v80, v40 offset:4096
    ds_read_b32 v81, v40 offset:7168
    ds_read_b32 v82, v40 offset:10240
    ds_read_b32 v83, v40 offset:13312
    ds_read_b32 v84, v40 offset:5120
    ds_read_b32 v85, v40 offset:8192
    ds_read_b32 v86, v40 offset:11264
    ds_read_b32 v87, v40 offset:14336
    ds_read_b32 v88, v40 offset:6144
    ds_read_b32 v89, v40 offset:9216
    ds_read_b32 v90, v40 offset:12288
    ds_read_b32 v91, v40 offset:15360
    s_waitcnt lgkmcnt(8)
    v_pk_add_f32 v[80:81], v[80:81], v[82:83]
    v_add_f32 v80, v80, v81
    v_cvt_pk_bf16_f32 v80, v80, v80
    ds_write_b16 v42, v80 offset:16384
    s_waitcnt lgkmcnt(5)
    v_pk_add_f32 v[84:85], v[84:85], v[86:87]
    v_add_f32 v84, v84, v85
    v_cvt_pk_bf16_f32 v84, v84, v84
    ds_write_b16 v42, v84 offset:16896
    s_waitcnt lgkmcnt(2)
    v_pk_add_f32 v[88:89], v[88:89], v[90:91]
    v_add_f32 v88, v88, v89
    v_cvt_pk_bf16_f32 v88, v88, v88
    ds_write_b16 v42, v88 offset:17408
    s_waitcnt lgkmcnt(0)
    s_barrier
    ds_read_u16 v80, v64 offset:16384
    ds_read_u16 v81, v65 offset:16384
    ds_read_u16 v82, v66 offset:16384
    ds_read_u16 v83, v67 offset:16384
    ds_read_u16 v84, v68 offset:16384
    ds_read_u16 v85, v69 offset:16384
    ds_read_u16 v86, v70 offset:16384
    ds_read_u16 v87, v71 offset:16384
    s_mul_i32 s27, s2, 4352
    s_add_u32 s27, s27, 29360144
    s_waitcnt lgkmcnt(0)
    v_lshl_or_b32 v88, v81, 16, v80
    v_lshl_or_b32 v89, v83, 16, v82
    v_lshl_or_b32 v90, v85, 16, v84
    v_lshl_or_b32 v91, v87, 16, v86
    buffer_store_dwordx4 v[88:91], v41, s[8:11], s27 offen sc1
    s_cmp_lg_u32 s3, 0
    s_cbranch_scc1 Lprep_fin
    ds_read_u16 v80, v72 offset:16384
    ds_read_u16 v81, v73 offset:16384
    ds_read_u16 v82, v74 offset:16384
    ds_read_u16 v83, v75 offset:16384
    ds_read_u16 v84, v76 offset:16384
    ds_read_u16 v85, v77 offset:16384
    ds_read_u16 v86, v78 offset:16384
    ds_read_u16 v87, v79 offset:16384
    s_add_u32 s27, s27, 4096
    v_cmp_gt_u32 vcc, 10, v0
    s_waitcnt lgkmcnt(0)
    v_lshl_or_b32 v92, v81, 16, v80
    v_lshl_or_b32 v93, v83, 16, v82
    v_lshl_or_b32 v94, v85, 16, v84
    v_lshl_or_b32 v95, v87, 16, v86
    s_and_saveexec_b64 s[28:29], vcc
    buffer_store_dwordx4 v[92:95], v41, s[8:11], s27 offen sc1
    s_branch Lprep_fin
Lprep_xt:
    s_load_dwordx2 s[6:7], s[0:1], 0
    s_sub_u32 s20, s2, 512
    s_lshl_b32 s20, s20, 2
    s_add_u32 s20, s20, s3
    s_and_b32 s21, s20, 7
    s_lshr_b32 s22, s20, 3
    v_lshrrev_b32 v4, 3, v1
    v_and_b32 v5, 7, v1
    v_bfe_u32 v6, v1, 4, 1
    v_lshlrev_b32 v7, 2, v6
    v_xor_b32 v5, v5, v7
    v_lshlrev_b32 v4, 10, v4
    v_lshl_add_u32 v4, v5, 4, v4
    s_lshl_b32 s23, s22, 16
    s_lshl_b32 s24, s21, 7
    s_add_u32 s23, s23, s24
    s_lshl_b32 s26, s3, 13
    v_lshrrev_b32 v8, 4, v1
    v_bfe_u32 v9, v1, 2, 2
    v_and_b32 v10, 3, v1
    v_lshlrev_b32 v11, 10, v8
    v_lshl_add_u32 v11, v9, 7, v11
    v_lshl_add_u32 v11, v10, 3, v11
    v_add_u32 v11, s26, v11
    v_lshrrev_b32 v9, 1, v9
    v_lshl_add_u32 v12, v9, 6, v11
    v_xor_b32 v9, 1, v9
    v_lshl_add_u32 v13, v9, 6, v11
    v_and_b32 v14, 15, v1
    v_mul_u32_u24 v14, 4224, v14
    v_lshl_add_u32 v14, v8, 4, v14
    s_mul_i32 s25, s21, 270336
    s_lshl_b32 s27, s22, 7
    s_add_u32 s25, s25, s27
    s_add_u32 s25, s25, 37748736
    s_waitcnt lgkmcnt(0)
    s_mov_b32 s8, s4
    s_mov_b32 s9, s5
    s_mov_b32 s10, 0x10000000
    s_mov_b32 s11, 0x00020000
    s_mov_b32 s12, s6
    s_mov_b32 s13, s7
    s_mov_b32 s14, 0x200000
    s_mov_b32 s15, 0x00020000
    s_add_u32 m0, s26, 0
    s_add_u32 s28, s23, 0
    buffer_load_dwordx4 v4, s[12:15], s28 offen lds
    s_add_u32 m0, s26, 1024
    s_add_u32 s28, s23, 8192
    buffer_load_dwordx4 v4, s[12:15], s28 offen lds
    s_add_u32 m0, s26, 2048
    s_add_u32 s28, s23, 16384
    buffer_load_dwordx4 v4, s[12:15], s28 offen lds
    s_add_u32 m0, s26, 3072
    s_add_u32 s28, s23, 24576
    buffer_load_dwordx4 v4, s[12:15], s28 offen lds
    s_add_u32 m0, s26, 4096
    s_add_u32 s28, s23, 32768
    buffer_load_dwordx4 v4, s[12:15], s28 offen lds
    s_add_u32 m0, s26, 5120
    s_add_u32 s28, s23, 40960
    buffer_load_dwordx4 v4, s[12:15], s28 offen lds
    s_add_u32 m0, s26, 6144
    s_add_u32 s28, s23, 49152
    buffer_load_dwordx4 v4, s[12:15], s28 offen lds
    s_add_u32 m0, s26, 7168
    s_add_u32 s28, s23, 57344
    buffer_load_dwordx4 v4, s[12:15], s28 offen lds
    s_waitcnt vmcnt(4)
    ds_read_b64_tr_b16 v[16:17], v12 offset:0
    ds_read_b64_tr_b16 v[18:19], v12 offset:512
    ds_read_b64_tr_b16 v[20:21], v12 offset:32
    ds_read_b64_tr_b16 v[22:23], v12 offset:544
    ds_read_b64_tr_b16 v[24:25], v13 offset:0
    ds_read_b64_tr_b16 v[26:27], v13 offset:512
    ds_read_b64_tr_b16 v[28:29], v13 offset:32
    ds_read_b64_tr_b16 v[30:31], v13 offset:544
    s_waitcnt lgkmcnt(6)
    s_add_u32 s28, s25, 0
    buffer_store_dwordx4 v[16:19], v14, s[8:11], s28 offen offset:0 sc1
    s_waitcnt lgkmcnt(4)
    s_add_u32 s28, s25, 67584
    buffer_store_dwordx4 v[20:23], v14, s[8:11], s28 offen offset:0 sc1
    s_waitcnt lgkmcnt(2)
    s_add_u32 s28, s25, 135168
    buffer_store_dwordx4 v[24:27], v14, s[8:11], s28 offen offset:0 sc1
    s_waitcnt lgkmcnt(0)
    s_add_u32 s28, s25, 202752
    buffer_store_dwordx4 v[28:31], v14, s[8:11], s28 offen offset:0 sc1
    s_waitcnt vmcnt(4)
    ds_read_b64_tr_b16 v[32:33], v12 offset:4096
    ds_read_b64_tr_b16 v[34:35], v12 offset:4608
    ds_read_b64_tr_b16 v[36:37], v12 offset:4128
    ds_read_b64_tr_b16 v[38:39], v12 offset:4640
    ds_read_b64_tr_b16 v[40:41], v13 offset:4096
    ds_read_b64_tr_b16 v[42:43], v13 offset:4608
    ds_read_b64_tr_b16 v[44:45], v13 offset:4128
    ds_read_b64_tr_b16 v[46:47], v13 offset:4640
    s_waitcnt lgkmcnt(6)
    s_add_u32 s28, s25, 0
    buffer_store_dwordx4 v[32:35], v14, s[8:11], s28 offen offset:64 sc1
    s_waitcnt lgkmcnt(4)
    s_add_u32 s28, s25, 67584
    buffer_store_dwordx4 v[36:39], v14, s[8:11], s28 offen offset:64 sc1
    s_waitcnt lgkmcnt(2)
    s_add_u32 s28, s25, 135168
    buffer_store_dwordx4 v[40:43], v14, s[8:11], s28 offen offset:64 sc1
    s_waitcnt lgkmcnt(0)
    s_add_u32 s28, s25, 202752
    buffer_store_dwordx4 v[44:47], v14, s[8:11], s28 offen offset:64 sc1
    s_branch Lprep_fin
Lprep_st:
    s_load_dwordx2 s[6:7], s[0:1], 0
    s_sub_u32 s20, s2, 576
    s_lshl_b32 s20, s20, 2
    s_add_u32 s20, s20, s3
    s_lshl_b32 s20, s20, 3
    v_lshrrev_b32 v3, 3, v1
    v_add_u32 v3, s20, v3
    v_and_b32 v4, 7, v1
    v_lshlrev_b32 v5, 10, v3
    v_lshl_add_u32 v5, v4, 4, v5
    v_mov_b32 v6, 0x3f803f80
    v_mov_b32 v8, 0
    v_mov_b32 v9, 0
    s_waitcnt lgkmcnt(0)
    s_mov_b32 s8, s4
    s_mov_b32 s9, s5
    s_mov_b32 s10, 0x10000000
    s_mov_b32 s11, 0x00020000
    s_mov_b32 s12, s6
    s_mov_b32 s13, s7
    s_mov_b32 s14, 0x200000
    s_mov_b32 s15, 0x00020000
    buffer_load_dwordx4 v[16:19], v5, s[12:15], 0 offen offset:0
    buffer_load_dwordx4 v[20:23], v5, s[12:15], 0 offen offset:128
    buffer_load_dwordx4 v[24:27], v5, s[12:15], 0 offen offset:256
    buffer_load_dwordx4 v[28:31], v5, s[12:15], 0 offen offset:384
    buffer_load_dwordx4 v[32:35], v5, s[12:15], 0 offen offset:512
    buffer_load_dwordx4 v[36:39], v5, s[12:15], 0 offen offset:640
    buffer_load_dwordx4 v[40:43], v5, s[12:15], 0 offen offset:768
    buffer_load_dwordx4 v[44:47], v5, s[12:15], 0 offen offset:896
    s_waitcnt vmcnt(7)
    v_dot2_f32_bf16 v8, v16, v6, v8
    v_dot2_f32_bf16 v9, v16, v16, v9
    v_dot2_f32_bf16 v8, v17, v6, v8
    v_dot2_f32_bf16 v9, v17, v17, v9
    v_dot2_f32_bf16 v8, v18, v6, v8
    v_dot2_f32_bf16 v9, v18, v18, v9
    v_dot2_f32_bf16 v8, v19, v6, v8
    v_dot2_f32_bf16 v9, v19, v19, v9
    s_waitcnt vmcnt(6)
    v_dot2_f32_bf16 v8, v20, v6, v8
    v_dot2_f32_bf16 v9, v20, v20, v9
    v_dot2_f32_bf16 v8, v21, v6, v8
    v_dot2_f32_bf16 v9, v21, v21, v9
    v_dot2_f32_bf16 v8, v22, v6, v8
    v_dot2_f32_bf16 v9, v22, v22, v9
    v_dot2_f32_bf16 v8, v23, v6, v8
    v_dot2_f32_bf16 v9, v23, v23, v9
    s_waitcnt vmcnt(5)
    v_dot2_f32_bf16 v8, v24, v6, v8
    v_dot2_f32_bf16 v9, v24, v24, v9
    v_dot2_f32_bf16 v8, v25, v6, v8
    v_dot2_f32_bf16 v9, v25, v25, v9
    v_dot2_f32_bf16 v8, v26, v6, v8
    v_dot2_f32_bf16 v9, v26, v26, v9
    v_dot2_f32_bf16 v8, v27, v6, v8
    v_dot2_f32_bf16 v9, v27, v27, v9
    s_waitcnt vmcnt(4)
    v_dot2_f32_bf16 v8, v28, v6, v8
    v_dot2_f32_bf16 v9, v28, v28, v9
    v_dot2_f32_bf16 v8, v29, v6, v8
    v_dot2_f32_bf16 v9, v29, v29, v9
    v_dot2_f32_bf16 v8, v30, v6, v8
    v_dot2_f32_bf16 v9, v30, v30, v9
    v_dot2_f32_bf16 v8, v31, v6, v8
    v_dot2_f32_bf16 v9, v31, v31, v9
    s_waitcnt vmcnt(3)
    v_dot2_f32_bf16 v8, v32, v6, v8
    v_dot2_f32_bf16 v9, v32, v32, v9
    v_dot2_f32_bf16 v8, v33, v6, v8
    v_dot2_f32_bf16 v9, v33, v33, v9
    v_dot2_f32_bf16 v8, v34, v6, v8
    v_dot2_f32_bf16 v9, v34, v34, v9
    v_dot2_f32_bf16 v8, v35, v6, v8
    v_dot2_f32_bf16 v9, v35, v35, v9
    s_waitcnt vmcnt(2)
    v_dot2_f32_bf16 v8, v36, v6, v8
    v_dot2_f32_bf16 v9, v36, v36, v9
    v_dot2_f32_bf16 v8, v37, v6, v8
    v_dot2_f32_bf16 v9, v37, v37, v9
    v_dot2_f32_bf16 v8, v38, v6, v8
    v_dot2_f32_bf16 v9, v38, v38, v9
    v_dot2_f32_bf16 v8, v39, v6, v8
    v_dot2_f32_bf16 v9, v39, v39, v9
    s_waitcnt vmcnt(1)
    v_dot2_f32_bf16 v8, v40, v6, v8
    v_dot2_f32_bf16 v9, v40, v40, v9
    v_dot2_f32_bf16 v8, v41, v6, v8
    v_dot2_f32_bf16 v9, v41, v41, v9
    v_dot2_f32_bf16 v8, v42, v6, v8
    v_dot2_f32_bf16 v9, v42, v42, v9
    v_dot2_f32_bf16 v8, v43, v6, v8
    v_dot2_f32_bf16 v9, v43, v43, v9
    s_waitcnt vmcnt(0)
    v_dot2_f32_bf16 v8, v44, v6, v8
    v_dot2_f32_bf16 v9, v44, v44, v9
    v_dot2_f32_bf16 v8, v45, v6, v8
    v_dot2_f32_bf16 v9, v45, v45, v9
    v_dot2_f32_bf16 v8, v46, v6, v8
    v_dot2_f32_bf16 v9, v46, v46, v9
    v_dot2_f32_bf16 v8, v47, v6, v8
    v_dot2_f32_bf16 v9, v47, v47, v9
    s_nop 3
    v_add_f32_dpp v8, v8, v8 quad_perm:[1,0,3,2] row_mask:0xf bank_mask:0xf
    v_add_f32_dpp v9, v9, v9 quad_perm:[1,0,3,2] row_mask:0xf bank_mask:0xf
    s_nop 1
    v_add_f32_dpp v8, v8, v8 quad_perm:[2,3,0,1] row_mask:0xf bank_mask:0xf
    v_add_f32_dpp v9, v9, v9 quad_perm:[2,3,0,1] row_mask:0xf bank_mask:0xf
    s_nop 1
    v_add_f32_dpp v8, v8, v8 row_half_mirror row_mask:0xf bank_mask:0xf
    v_add_f32_dpp v9, v9, v9 row_half_mirror row_mask:0xf bank_mask:0xf
    v_lshlrev_b32 v10, 3, v3
    s_mov_b32 s21, 33554432
    v_cmp_eq_u32 vcc, 0, v4
    s_and_saveexec_b64 s[28:29], vcc
    buffer_store_dwordx2 v[8:9], v10, s[8:11], s21 offen
    s_branch Lprep_fin
Lprep_w1:
    s_load_dwordx2 s[6:7], s[0:1], 64
    s_sub_u32 s20, s2, 640
    s_lshl_b32 s26, s3, 13
    v_lshrrev_b32 v4, 2, v1
    v_and_b32 v5, 3, v1
    v_bfe_u32 v8, v1, 4, 1
    v_lshrrev_b32 v9, 5, v1
    v_bfe_u32 v10, v1, 2, 2
    v_lshlrev_b32 v6, 4, v1
    v_lshlrev_b32 v11, 6, v10
    v_lshl_add_u32 v11, v8, 5, v11
    v_lshl_add_u32 v11, v5, 3, v11
    v_add_u32 v11, s26, v11
    v_lshl_add_u32 v11, v9, 9, v11
    v_mul_u32_u24 v4, 3584, v4
    v_lshl_add_u32 v4, v5, 4, v4
    s_lshl_b32 s21, s20, 6
    s_mul_i32 s22, s3, 458752
    s_add_u32 s21, s21, s22
    s_lshl_b32 s23, s20, 15
    s_add_u32 s23, s23, 25165824
    s_lshl_b32 s24, s3, 13
    s_add_u32 s24, s24, s23
    v_mov_b32 v7, 0x3f803f80
    v_mov_b32 v3, 0
    s_waitcnt lgkmcnt(0)
    s_mov_b32 s8, s4
    s_mov_b32 s9, s5
    s_mov_b32 s10, 0x10000000
    s_mov_b32 s11, 0x00020000
    s_mov_b32 s12, s6
    s_mov_b32 s13, s7
    s_mov_b32 s14, 0x1c0000
    s_mov_b32 s15, 0x00020000
    s_add_u32 m0, s26, 0
    s_add_u32 s28, s21, 0
    buffer_load_dwordx4 v4, s[12:15], s28 offen lds
    s_add_u32 m0, s26, 1024
    s_add_u32 s28, s21, 57344
    buffer_load_dwordx4 v4, s[12:15], s28 offen lds
    s_add_u32 m0, s26, 2048
    s_add_u32 s28, s21, 114688
    buffer_load_dwordx4 v4, s[12:15], s28 offen lds
    s_add_u32 m0, s26, 3072
    s_add_u32 s28, s21, 172032
    buffer_load_dwordx4 v4, s[12:15], s28 offen lds
    s_add_u32 m0, s26, 4096
    s_add_u32 s28, s21, 229376
    buffer_load_dwordx4 v4, s[12:15], s28 offen lds
    s_add_u32 m0, s26, 5120
    s_add_u32 s28, s21, 286720
    buffer_load_dwordx4 v4, s[12:15], s28 offen lds
    s_add_u32 m0, s26, 6144
    s_add_u32 s28, s21, 344064
    buffer_load_dwordx4 v4, s[12:15], s28 offen lds
    s_add_u32 m0, s26, 7168
    s_add_u32 s28, s21, 401408
    buffer_load_dwordx4 v4, s[12:15], s28 offen lds
    s_waitcnt vmcnt(4)
    ds_read_b64_tr_b16 v[16:17], v11 offset:0
    ds_read_b64_tr_b16 v[18:19], v11 offset:256
    ds_read_b64_tr_b16 v[20:21], v11 offset:1024
    ds_read_b64_tr_b16 v[22:23], v11 offset:1280
    ds_read_b64_tr_b16 v[24:25], v11 offset:2048
    ds_read_b64_tr_b16 v[26:27], v11 offset:2304
    ds_read_b64_tr_b16 v[28:29], v11 offset:3072
    ds_read_b64_tr_b16 v[30:31], v11 offset:3328
    s_add_u32 s25, s24, 0
    s_waitcnt lgkmcnt(6)
    buffer_store_dwordx4 v[16:19], v6, s[8:11], s25 offen offset:0 sc1
    v_dot2_f32_bf16 v3, v16, v7, v3
    v_dot2_f32_bf16 v3, v17, v7, v3
    v_dot2_f32_bf16 v3, v18, v7, v3
    v_dot2_f32_bf16 v3, v19, v7, v3
    s_waitcnt lgkmcnt(4)
    buffer_store_dwordx4 v[20:23], v6, s[8:11], s25 offen offset:1024 sc1
    v_dot2_f32_bf16 v3, v20, v7, v3
    v_dot2_f32_bf16 v3, v21, v7, v3
    v_dot2_f32_bf16 v3, v22, v7, v3
    v_dot2_f32_bf16 v3, v23, v7, v3
    s_waitcnt lgkmcnt(2)
    buffer_store_dwordx4 v[24:27], v6, s[8:11], s25 offen offset:2048 sc1
    v_dot2_f32_bf16 v3, v24, v7, v3
    v_dot2_f32_bf16 v3, v25, v7, v3
    v_dot2_f32_bf16 v3, v26, v7, v3
    v_dot2_f32_bf16 v3, v27, v7, v3
    s_waitcnt lgkmcnt(0)
    buffer_store_dwordx4 v[28:31], v6, s[8:11], s25 offen offset:3072 sc1
    v_dot2_f32_bf16 v3, v28, v7, v3
    v_dot2_f32_bf16 v3, v29, v7, v3
    v_dot2_f32_bf16 v3, v30, v7, v3
    v_dot2_f32_bf16 v3, v31, v7, v3
    s_waitcnt vmcnt(4)
    ds_read_b64_tr_b16 v[32:33], v11 offset:4096
    ds_read_b64_tr_b16 v[34:35], v11 offset:4352
    ds_read_b64_tr_b16 v[36:37], v11 offset:5120
    ds_read_b64_tr_b16 v[38:39], v11 offset:5376
    ds_read_b64_tr_b16 v[40:41], v11 offset:6144
    ds_read_b64_tr_b16 v[42:43], v11 offset:6400
    ds_read_b64_tr_b16 v[44:45], v11 offset:7168
    ds_read_b64_tr_b16 v[46:47], v11 offset:7424
    s_add_u32 s25, s24, 4096
    s_waitcnt lgkmcnt(6)
    buffer_store_dwordx4 v[32:35], v6, s[8:11], s25 offen offset:0 sc1
    v_dot2_f32_bf16 v3, v32, v7, v3
    v_dot2_f32_bf16 v3, v33, v7, v3
    v_dot2_f32_bf16 v3, v34, v7, v3
    v_dot2_f32_bf16 v3, v35, v7, v3
    s_waitcnt lgkmcnt(4)
    buffer_store_dwordx4 v[36:39], v6, s[8:11], s25 offen offset:1024 sc1
    v_dot2_f32_bf16 v3, v36, v7, v3
    v_dot2_f32_bf16 v3, v37, v7, v3
    v_dot2_f32_bf16 v3, v38, v7, v3
    v_dot2_f32_bf16 v3, v39, v7, v3
    s_waitcnt lgkmcnt(2)
    buffer_store_dwordx4 v[40:43], v6, s[8:11], s25 offen offset:2048 sc1
    v_dot2_f32_bf16 v3, v40, v7, v3
    v_dot2_f32_bf16 v3, v41, v7, v3
    v_dot2_f32_bf16 v3, v42, v7, v3
    v_dot2_f32_bf16 v3, v43, v7, v3
    s_waitcnt lgkmcnt(0)
    buffer_store_dwordx4 v[44:47], v6, s[8:11], s25 offen offset:3072 sc1
    v_dot2_f32_bf16 v3, v44, v7, v3
    v_dot2_f32_bf16 v3, v45, v7, v3
    v_dot2_f32_bf16 v3, v46, v7, v3
    v_dot2_f32_bf16 v3, v47, v7, v3
    s_nop 3
    v_lshlrev_b32 v9, 2, v0
    s_barrier
    ds_write_b32 v9, v3
    s_waitcnt lgkmcnt(0)
    s_barrier
    s_cmp_lg_u32 s3, 0
    s_cbranch_scc1 Lprep_fin
    v_and_b32 v9, 31, v1
    v_lshlrev_b32 v9, 2, v9
    ds_read_b32 v16, v9 offset:0
    ds_read_b32 v17, v9 offset:128
    ds_read_b32 v18, v9 offset:256
    ds_read_b32 v19, v9 offset:384
    ds_read_b32 v20, v9 offset:512
    ds_read_b32 v21, v9 offset:640
    ds_read_b32 v22, v9 offset:768
    ds_read_b32 v23, v9 offset:896
    s_waitcnt lgkmcnt(0)
    v_add_f32 v16, v16, v17
    v_add_f32 v18, v18, v19
    v_add_f32 v20, v20, v21
    v_add_f32 v22, v22, v23
    v_add_f32 v16, v16, v18
    v_add_f32 v20, v20, v22
    v_add_f32 v16, v16, v20
    s_lshl_b32 s25, s20, 7
    s_add_u32 s25, s25, 33685504
    v_cmp_gt_u32 vcc, 32, v1
    s_and_saveexec_b64 s[28:29], vcc
    buffer_store_dword v16, v9, s[8:11], s25 offen
    s_branch Lprep_fin
Lprep_w2:
    s_load_dwordx2 s[6:7], s[0:1], 80
    s_sub_u32 s20, s2, 696
    s_lshl_b32 s20, s20, 2
    s_add_u32 s20, s20, s3
    s_mul_i32 s22, s20, 4682
    s_lshr_b32 s22, s22, 16
    s_mul_i32 s23, s22, 14
    s_sub_u32 s23, s20, s23
    s_lshl_b32 s26, s3, 13
    v_lshrrev_b32 v4, 2, v1
    v_and_b32 v5, 3, v1
    v_bfe_u32 v8, v1, 4, 1
    v_lshrrev_b32 v9, 5, v1
    v_bfe_u32 v10, v1, 2, 2
    v_lshlrev_b32 v6, 4, v1
    v_lshlrev_b32 v11, 6, v10
    v_lshl_add_u32 v11, v8, 5, v11
    v_lshl_add_u32 v11, v5, 3, v11
    v_add_u32 v11, s26, v11
    v_lshl_add_u32 v11, v9, 8, v11
    v_lshlrev_b32 v4, 10, v4
    v_lshl_add_u32 v4, v5, 4, v4
    s_lshl_b32 s21, s22, 6
    s_lshl_b32 s24, s23, 17
    s_add_u32 s21, s21, s24
    s_lshl_b32 s24, s20, 13
    s_add_u32 s24, s24, 27262976
    s_waitcnt lgkmcnt(0)
    s_mov_b32 s8, s4
    s_mov_b32 s9, s5
    s_mov_b32 s10, 0x10000000
    s_mov_b32 s11, 0x00020000
    s_mov_b32 s12, s6
    s_mov_b32 s13, s7
    s_mov_b32 s14, 0x1c0000
    s_mov_b32 s15, 0x00020000
    s_add_u32 m0, s26, 0
    s_add_u32 s28, s21, 0
    buffer_load_dwordx4 v4, s[12:15], s28 offen lds
    s_add_u32 m0, s26, 1024
    s_add_u32 s28, s21, 16384
    buffer_load_dwordx4 v4, s[12:15], s28 offen lds
    s_add_u32 m0, s26, 2048
    s_add_u32 s28, s21, 32768
    buffer_load_dwordx4 v4, s[12:15], s28 offen lds
    s_add_u32 m0, s26, 3072
    s_add_u32 s28, s21, 49152
    buffer_load_dwordx4 v4, s[12:15], s28 offen lds
    s_add_u32 m0, s26, 4096
    s_add_u32 s28, s21, 65536
    buffer_load_dwordx4 v4, s[12:15], s28 offen lds
    s_add_u32 m0, s26, 5120
    s_add_u32 s28, s21, 81920
    buffer_load_dwordx4 v4, s[12:15], s28 offen lds
    s_add_u32 m0, s26, 6144
    s_add_u32 s28, s21, 98304
    buffer_load_dwordx4 v4, s[12:15], s28 offen lds
    s_add_u32 m0, s26, 7168
    s_add_u32 s28, s21, 114688
    buffer_load_dwordx4 v4, s[12:15], s28 offen lds
    s_waitcnt vmcnt(4)
    ds_read_b64_tr_b16 v[16:17], v11 offset:0
    ds_read_b64_tr_b16 v[18:19], v11 offset:512
    ds_read_b64_tr_b16 v[20:21], v11 offset:1024
    ds_read_b64_tr_b16 v[22:23], v11 offset:1536
    ds_read_b64_tr_b16 v[24:25], v11 offset:2048
    ds_read_b64_tr_b16 v[26:27], v11 offset:2560
    ds_read_b64_tr_b16 v[28:29], v11 offset:3072
    ds_read_b64_tr_b16 v[30:31], v11 offset:3584
    s_add_u32 s25, s24, 0
    s_waitcnt lgkmcnt(6)
    buffer_store_dwordx4 v[16:19], v6, s[8:11], s25 offen offset:0 sc1
    s_waitcnt lgkmcnt(4)
    buffer_store_dwordx4 v[20:23], v6, s[8:11], s25 offen offset:1024 sc1
    s_waitcnt lgkmcnt(2)
    buffer_store_dwordx4 v[24:27], v6, s[8:11], s25 offen offset:2048 sc1
    s_waitcnt lgkmcnt(0)
    buffer_store_dwordx4 v[28:31], v6, s[8:11], s25 offen offset:3072 sc1
    s_waitcnt vmcnt(4)
    ds_read_b64_tr_b16 v[32:33], v11 offset:4096
    ds_read_b64_tr_b16 v[34:35], v11 offset:4608
    ds_read_b64_tr_b16 v[36:37], v11 offset:5120
    ds_read_b64_tr_b16 v[38:39], v11 offset:5632
    ds_read_b64_tr_b16 v[40:41], v11 offset:6144
    ds_read_b64_tr_b16 v[42:43], v11 offset:6656
    ds_read_b64_tr_b16 v[44:45], v11 offset:7168
    ds_read_b64_tr_b16 v[46:47], v11 offset:7680
    s_add_u32 s25, s24, 4096
    s_waitcnt lgkmcnt(6)
    buffer_store_dwordx4 v[32:35], v6, s[8:11], s25 offen offset:0 sc1
    s_waitcnt lgkmcnt(4)
    buffer_store_dwordx4 v[36:39], v6, s[8:11], s25 offen offset:1024 sc1
    s_waitcnt lgkmcnt(2)
    buffer_store_dwordx4 v[40:43], v6, s[8:11], s25 offen offset:2048 sc1
    s_waitcnt lgkmcnt(0)
    buffer_store_dwordx4 v[44:47], v6, s[8:11], s25 offen offset:3072 sc1
    s_branch Lprep_fin
Lprep_z:
    s_mov_b32 s8, s4
    s_mov_b32 s9, s5
    s_mov_b32 s10, 0x10000000
    s_mov_b32 s11, 0x00020000
    v_lshlrev_b32 v3, 4, v0
    v_mov_b32 v4, 0
    v_mov_b32 v5, 0
    v_mov_b32 v6, 0
    v_mov_b32 v7, 0
    s_mov_b32 s20, 33619968
    buffer_store_dwordx4 v[4:7], v3, s[8:11], s20 offen
    s_mov_b32 s20, 33624064
    buffer_store_dwordx4 v[4:7], v3, s[8:11], s20 offen
    s_mov_b32 s20, 33628160
    buffer_store_dwordx4 v[4:7], v3, s[8:11], s20 offen
    s_mov_b32 s20, 33632256
    buffer_store_dwordx4 v[4:7], v3, s[8:11], s20 offen
    s_mov_b32 s20, 33816576
    buffer_store_dwordx4 v[4:7], v3, s[8:11], s20 offen
    s_mov_b32 s20, 33820672
    buffer_store_dwordx4 v[4:7], v3, s[8:11], s20 offen
    s_mov_b32 s20, 33824768
    buffer_store_dwordx4 v[4:7], v3, s[8:11], s20 offen
    s_mov_b32 s20, 33828864
    buffer_store_dwordx4 v[4:7], v3, s[8:11], s20 offen
    s_mov_b32 s20, 33832960
    buffer_store_dwordx4 v[4:7], v3, s[8:11], s20 offen
    s_mov_b32 s20, 33837056
    buffer_store_dwordx4 v[4:7], v3, s[8:11], s20 offen
    s_mov_b32 s20, 33841152
    buffer_store_dwordx4 v[4:7], v3, s[8:11], s20 offen
    s_mov_b32 s20, 33845248
    buffer_store_dwordx4 v[4:7], v3, s[8:11], s20 offen
    s_mov_b32 s20, 33849344
    buffer_store_dwordx4 v[4:7], v3, s[8:11], s20 offen
    s_mov_b32 s20, 33853440
    buffer_store_dwordx4 v[4:7], v3, s[8:11], s20 offen
    s_mov_b32 s20, 33857536
    buffer_store_dwordx4 v[4:7], v3, s[8:11], s20 offen
    s_mov_b32 s20, 33861632
    buffer_store_dwordx4 v[4:7], v3, s[8:11], s20 offen
    s_mov_b32 s20, 33865728
    buffer_store_dwordx4 v[4:7], v3, s[8:11], s20 offen
    s_branch Lprep_fin
Lprep_pf:
    s_mov_b32 s8, s4
    s_mov_b32 s9, s5
    s_mov_b32 s10, 0x10000000
    s_mov_b32 s11, 0x00020000
    s_getpc_b64 s[20:21]
Lprep_pc:
    s_add_u32 s20, s20, cm1_kernel-Lprep_pc
    s_addc_u32 s21, s21, 0
    s_mov_b32 s22, Ltext_end-cm1_kernel-16
    v_lshlrev_b32 v3, 4, v0
Lprep_pf_loop:
    v_cmp_ge_u32 vcc, s22, v3
    s_and_saveexec_b64 s[28:29], vcc
    s_cbranch_execz Lprep_fin
    global_load_dwordx4 v[4:7], v3, s[20:21]
    v_add_u32 v3, 4096, v3
    s_branch Lprep_pf_loop
Lprep_fin:
Lprep_end:
    s_endpgm
.p2align 8
.type Lkg_tab,@object
Lkg_tab:
    .long 0x00000000, 0x00000000, 0x43800000, 0x44800000, 0x00001000, 0x00001400, 0x00001408, 0x00001800
    .long 0x41000000, 0x3f800000, 0x43810000, 0x44900000, 0x00001020, 0x00001410, 0x00001418, 0x00001804
    .long 0x41800000, 0x40000000, 0x43820000, 0x44a00000, 0x00001040, 0x00001420, 0x00001428, 0x00001808
    .long 0x41c00000, 0x40400000, 0x43830000, 0x44b00000, 0x00001060, 0x00001430, 0x00001438, 0x0000180c
    .long 0x42000000, 0x40800000, 0x43c00000, 0x44c00000, 0x00001080, 0x00001440, 0x00001448, 0x00001810
    .long 0x42200000, 0x40a00000, 0x43c10000, 0x44d00000, 0x000010a0, 0x00001450, 0x00001458, 0x00001814
    .long 0x42400000, 0x40c00000, 0x43c20000, 0x44e00000, 0x000010c0, 0x00001460, 0x00001468, 0x00001818
    .long 0x42600000, 0x40e00000, 0x43c30000, 0x44f00000, 0x000010e0, 0x00001470, 0x00001478, 0x0000181c
    .long 0x42800000, 0x43000000, 0x44000000, 0x45000000, 0x00001100, 0x00001480, 0x00001488, 0x00001820
    .long 0x42900000, 0x43010000, 0x44010000, 0x45000000, 0x00001120, 0x00001490, 0x00001498, 0x00001824
    .long 0x42a00000, 0x43020000, 0x44200000, 0x45000000, 0x00001140, 0x000014a0, 0x000014a8, 0x00001828
    .long 0x42b00000, 0x43030000, 0x44210000, 0x45000000, 0x00001160, 0x000014b0, 0x000014b8, 0x0000182c
    .long 0x42c00000, 0x43040000, 0x44400000, 0x45000000, 0x00001180, 0x000014c0, 0x000014c8, 0x00001830
    .long 0x42d00000, 0x43050000, 0x44410000, 0x45000000, 0x000011a0, 0x000014d0, 0x000014d8, 0x00001834
    .long 0x42e00000, 0x43060000, 0x44600000, 0x45000000, 0x000011c0, 0x000014e0, 0x000014e8, 0x00001838
    .long 0x42f00000, 0x43070000, 0x44610000, 0x45000000, 0x000011e0, 0x000014f0, 0x000014f8, 0x0000183c
    .long 0x00000000, 0x00000000, 0x43800000, 0x44800000, 0x00001010, 0x00001500, 0x00001508, 0x00001900
    .long 0x41000000, 0x3f800000, 0x43810000, 0x44900000, 0x00001030, 0x00001510, 0x00001518, 0x00001904
    .long 0x41800000, 0x40000000, 0x43820000, 0x44a00000, 0x00001050, 0x00001520, 0x00001528, 0x00001908
    .long 0x41c00000, 0x40400000, 0x43830000, 0x44b00000, 0x00001070, 0x00001530, 0x00001538, 0x0000190c
    .long 0x42000000, 0x40800000, 0x43c00000, 0x44c00000, 0x00001090, 0x00001540, 0x00001548, 0x00001910
    .long 0x42200000, 0x40a00000, 0x43c10000, 0x44d00000, 0x000010b0, 0x00001550, 0x00001558, 0x00001914
    .long 0x42400000, 0x40c00000, 0x43c20000, 0x44e00000, 0x000010d0, 0x00001560, 0x00001568, 0x00001918
    .long 0x42600000, 0x40e00000, 0x43c30000, 0x44f00000, 0x000010f0, 0x00001570, 0x00001578, 0x0000191c
    .long 0x42800000, 0x43000000, 0x44000000, 0x45000000, 0x00001110, 0x00001580, 0x00001588, 0x00001920
    .long 0x42900000, 0x43010000, 0x44010000, 0x45000000, 0x00001130, 0x00001590, 0x00001598, 0x00001924
    .long 0x42a00000, 0x43020000, 0x44200000, 0x45000000, 0x00001150, 0x000015a0, 0x000015a8, 0x00001928
    .long 0x42b00000, 0x43030000, 0x44210000, 0x45000000, 0x00001170, 0x000015b0, 0x000015b8, 0x0000192c
    .long 0x42c00000, 0x43040000, 0x44400000, 0x45000000, 0x00001190, 0x000015c0, 0x000015c8, 0x00001930
    .long 0x42d00000, 0x43050000, 0x44410000, 0x45000000, 0x000011b0, 0x000015d0, 0x000015d8, 0x00001934
    .long 0x42e00000, 0x43060000, 0x44600000, 0x45000000, 0x000011d0, 0x000015e0, 0x000015e8, 0x00001938
    .long 0x42f00000, 0x43070000, 0x44610000, 0x45000000, 0x000011f0, 0x000015f0, 0x000015f8, 0x0000193c
    .long 0x00000000, 0x00000000, 0x43800000, 0x44800000, 0x00001200, 0x00001600, 0x00001680, 0x00001a00
    .long 0x41000000, 0x3f800000, 0x43810000, 0x44900000, 0x00001220, 0x00001608, 0x00001688, 0x00001a04
    .long 0x41800000, 0x40000000, 0x43820000, 0x44a00000, 0x00001240, 0x00001610, 0x00001690, 0x00001a08
    .long 0x41c00000, 0x40400000, 0x43830000, 0x44b00000, 0x00001260, 0x00001618, 0x00001698, 0x00001a0c
    .long 0x42000000, 0x40800000, 0x43c00000, 0x44c00000, 0x00001280, 0x00001620, 0x000016a0, 0x00001a10
    .long 0x42200000, 0x40a00000, 0x43c10000, 0x44d00000, 0x000012a0, 0x00001628, 0x000016a8, 0x00001a14
    .long 0x42400000, 0x40c00000, 0x43c20000, 0x44e00000, 0x000012c0, 0x00001630, 0x000016b0, 0x00001a18
    .long 0x42600000, 0x40e00000, 0x43c30000, 0x44f00000, 0x000012e0, 0x00001638, 0x000016b8, 0x00001a1c
    .long 0x42800000, 0x43000000, 0x44000000, 0x45000000, 0x00001300, 0x00001640, 0x000016c0, 0x00001a20
    .long 0x42900000, 0x43010000, 0x44010000, 0x45000000, 0x00001320, 0x00001648, 0x000016c8, 0x00001a24
    .long 0x42a00000, 0x43020000, 0x44200000, 0x45000000, 0x00001340, 0x00001650, 0x000016d0, 0x00001a28
    .long 0x42b00000, 0x43030000, 0x44210000, 0x45000000, 0x00001360, 0x00001658, 0x000016d8, 0x00001a2c
    .long 0x42c00000, 0x43040000, 0x44400000, 0x45000000, 0x00001380, 0x00001660, 0x000016e0, 0x00001a30
    .long 0x42d00000, 0x43050000, 0x44410000, 0x45000000, 0x000013a0, 0x00001668, 0x000016e8, 0x00001a34
    .long 0x42e00000, 0x43060000, 0x44600000, 0x45000000, 0x000013c0, 0x00001670, 0x000016f0, 0x00001a38
    .long 0x42f00000, 0x43070000, 0x44610000, 0x45000000, 0x000013e0, 0x00001678, 0x000016f8, 0x00001a3c
    .long 0x00000000, 0x00000000, 0x43800000, 0x44800000, 0x00001210, 0x00001700, 0x00001780, 0x00001b00
    .long 0x41000000, 0x3f800000, 0x43810000, 0x44900000, 0x00001230, 0x00001708, 0x00001788, 0x00001b04
    .long 0x41800000, 0x40000000, 0x43820000, 0x44a00000, 0x00001250, 0x00001710, 0x00001790, 0x00001b08
    .long 0x41c00000, 0x40400000, 0x43830000, 0x44b00000, 0x00001270, 0x00001718, 0x00001798, 0x00001b0c
    .long 0x42000000, 0x40800000, 0x43c00000, 0x44c00000, 0x00001290, 0x00001720, 0x000017a0, 0x00001b10
    .long 0x42200000, 0x40a00000, 0x43c10000, 0x44d00000, 0x000012b0, 0x00001728, 0x000017a8, 0x00001b14
    .long 0x42400000, 0x40c00000, 0x43c20000, 0x44e00000, 0x000012d0, 0x00001730, 0x000017b0, 0x00001b18
    .long 0x42600000, 0x40e00000, 0x43c30000, 0x44f00000, 0x000012f0, 0x00001738, 0x000017b8, 0x00001b1c
    .long 0x42800000, 0x43000000, 0x44000000, 0x45000000, 0x00001310, 0x00001740, 0x000017c0, 0x00001b20
    .long 0x42900000, 0x43010000, 0x44010000, 0x45000000, 0x00001330, 0x00001748, 0x000017c8, 0x00001b24
    .long 0x42a00000, 0x43020000, 0x44200000, 0x45000000, 0x00001350, 0x00001750, 0x000017d0, 0x00001b28
    .long 0x42b00000, 0x43030000, 0x44210000, 0x45000000, 0x00001370, 0x00001758, 0x000017d8, 0x00001b2c
    .long 0x42c00000, 0x43040000, 0x44400000, 0x45000000, 0x00001390, 0x00001760, 0x000017e0, 0x00001b30
    .long 0x42d00000, 0x43050000, 0x44410000, 0x45000000, 0x000013b0, 0x00001768, 0x000017e8, 0x00001b34
    .long 0x42e00000, 0x43060000, 0x44600000, 0x45000000, 0x000013d0, 0x00001770, 0x000017f0, 0x00001b38
    .long 0x42f00000, 0x43070000, 0x44610000, 0x45000000, 0x000013f0, 0x00001778, 0x000017f8, 0x00001b3c
    .long 0x06000600, 0x06000600, 0x06000600, 0x06000600, 0x06000600, 0x06000600, 0x06000600, 0x06000600
    .long 0x06000600, 0x06000600, 0x06000600, 0x06000600, 0x06000600, 0x06000600, 0x06000600, 0x06000600
    .long 0x06000600, 0x06000600, 0x06000600, 0x06000600, 0x06000600, 0x06000600, 0x06000600, 0x06000600
    .long 0x05000600, 0x05000500, 0x04fe0500, 0x04fe04fe, 0x04fe04fe, 0x04fe04fe, 0x04fc04fc, 0x04fc04fc
    .long 0x04fc04fc, 0x04fc04fc, 0x04fa04fc, 0x04fa04fa, 0x04fa04fa, 0x04fa04fa, 0x04f804f8, 0x04f804f8
    .long 0x04f804f8, 0x04f804f8, 0x04f604f8, 0x04f604f6, 0x04f604f6, 0x04f604f6, 0x04f404f4, 0x04f404f4
    .long 0x04f404f4, 0x04f404f4, 0x04f204f4, 0x04f204f2, 0x04f204f2, 0x04f204f2, 0x04f004f0, 0x04f004f0
    .long 0x04f004f0, 0x04f004f0, 0x04ee04f0, 0x04ee04ee, 0x04ee04ee, 0x04ee04ee, 0x04ec04ec, 0x04ec04ec
    .long 0x04ec04ec, 0x04ec04ec, 0x04ea04ec, 0x04ea04ea, 0x04ea04ea, 0x04ea04ea, 0x04e804e8, 0x04e804e8
    .long 0x04e804e8, 0x04e804e8, 0x04e604e8, 0x04e604e6, 0x04e604e6, 0x04e604e6, 0x04e404e4, 0x04e404e4
    .long 0x04e404e4, 0x04e404e4, 0x04e204e4, 0x04e204e2, 0x04e204e2, 0x04e204e2, 0x04e004e0, 0x04e004e0
    .long 0x04e004e0, 0x04e004e0, 0x04de04e0, 0x04de04de, 0x04de04de, 0x04de04de, 0x04dc04dc, 0x04dc04dc
    .long 0x04dc04dc, 0x04dc04dc, 0x04da04dc, 0x04da04da, 0x04da04da, 0x04da04da, 0x04d804d8, 0x04d804d8
    .long 0x04d804d8, 0x04d804d8, 0x04d604d8, 0x04d604d6, 0x04d604d6, 0x04d604d6, 0x04d404d4, 0x04d404d4
    .long 0x04d404d4, 0x04d404d4, 0x04d204d4, 0x04d204d2, 0x04d204d2, 0x04d204d2, 0x04d004d0, 0x04d004d0
    .long 0x04d004d0, 0x04d004d0, 0x04ce04d0, 0x04ce04ce, 0x04ce04ce, 0x04ce04ce, 0x04cc04cc, 0x04cc04cc
    .long 0x04cc04cc, 0x04cc04cc, 0x04ca04cc, 0x04ca04ca, 0x04ca04ca, 0x04ca04ca, 0x04c804c8, 0x04c804c8
    .long 0x04c804c8, 0x04c804c8, 0x04c604c8, 0x04c604c6, 0x04c604c6, 0x04c604c6, 0x04c404c4, 0x04c404c4
    .long 0x04c404c4, 0x04c404c4, 0x04c204c4, 0x04c204c2, 0x04c204c2, 0x04c204c2, 0x04c004c0, 0x04c004c0
    .long 0x04c004c0, 0x04c004c0, 0x04be04c0, 0x04be04be, 0x04be04be, 0x04be04be, 0x04bc04bc, 0x04bc04bc
    .long 0x04bc04bc, 0x04bc04bc, 0x04ba04bc, 0x04ba04ba, 0x04ba04ba, 0x04ba04ba, 0x04b804b8, 0x04b804b8
    .long 0x04b804b8, 0x04b804b8, 0x04b604b8, 0x04b604b6, 0x04b604b6, 0x04b604b6, 0x04b404b4, 0x04b404b4
    .long 0x04b404b4, 0x04b404b4, 0x04b204b4, 0x04b204b2, 0x04b204b2, 0x04b204b2, 0x04b004b0, 0x04b004b0
    .long 0x04b004b0, 0x04b004b0, 0x04ae04b0, 0x04ae04ae, 0x04ae04ae, 0x04ae04ae, 0x04ac04ac, 0x04ac04ac
    .long 0x04ac04ac, 0x04ac04ac, 0x04aa04ac, 0x04aa04aa, 0x04aa04aa, 0x04aa04aa, 0x04a804a8, 0x04a804a8
    .long 0x04a804a8, 0x04a804a8, 0x04a604a8, 0x04a604a6, 0x04a604a6, 0x04a604a6, 0x04a404a4, 0x04a404a4
    .long 0x04a404a4, 0x04a404a4, 0x04a204a4, 0x04a204a2, 0x04a204a2, 0x04a204a2, 0x04a004a0, 0x04a004a0
    .long 0x04a004a0, 0x04a004a0, 0x049e04a0, 0x049e049e, 0x049e049e, 0x049e049e, 0x049c049c, 0x049c049c
    .long 0x049c049c, 0x049c049c, 0x049a049c, 0x049a049a, 0x049a049a, 0x049a049a, 0x04980498, 0x04980498
    .long 0x04980498, 0x04980498, 0x04960498, 0x04960496, 0x04960496, 0x04960496, 0x04940494, 0x04940494
    .long 0x04940494, 0x04940494, 0x04920494, 0x04920492, 0x04920492, 0x04920492, 0x04900490, 0x04900490
    .long 0x04900490, 0x04900490, 0x048e0490, 0x048e048e, 0x048e048e, 0x048e048e, 0x048c048c, 0x048c048c
    .long 0x048c048c, 0x048c048c, 0x048a048c, 0x048a048a, 0x048a048a, 0x048a048a, 0x04880488, 0x04880488
    .long 0x04880488, 0x04880488, 0x04860488, 0x04860486, 0x04860486, 0x04860486, 0x04840484, 0x04840484
    .long 0x04840484, 0x04840484, 0x04820484, 0x04820482, 0x04820482, 0x04820482, 0x04800480, 0x04800480
    .long 0x04800480, 0x04800480, 0x047e0480, 0x047e047e, 0x047e047e, 0x047e047e, 0x047c047c, 0x047c047c
    .long 0x047c047c, 0x047c047c, 0x047a047c, 0x047a047a, 0x047a047a, 0x047a047a, 0x04780478, 0x04780478
    .long 0x04780478, 0x04780478, 0x04760478, 0x04760476, 0x04760476, 0x04760476, 0x04740474, 0x04740474
    .long 0x04740474, 0x04740474, 0x04720474, 0x04720472, 0x04720472, 0x04720472, 0x04700470, 0x04700470
    .long 0x04700470, 0x04700470, 0x046e0470, 0x046e046e, 0x046e046e, 0x046e046e, 0x046c046c, 0x046c046c
    .long 0x046c046c, 0x046c046c, 0x046a046c, 0x046a046a, 0x046a046a, 0x046a046a, 0x04680468, 0x04680468
    .long 0x04680468, 0x04680468, 0x04660468, 0x04660466, 0x04660466, 0x04660466, 0x04640464, 0x04640464
    .long 0x04640464, 0x04640464, 0x04620464, 0x04620462, 0x04620462, 0x04620462, 0x04600460, 0x04600460
    .long 0x04600460, 0x04600460, 0x045e0460, 0x045e045e, 0x045e045e, 0x045e045e, 0x045c045c, 0x045c045c
    .long 0x045c045c, 0x045c045c, 0x045a045c, 0x045a045a, 0x045a045a, 0x045a045a, 0x04580458, 0x04580458
    .long 0x04580458, 0x04580458, 0x04560458, 0x04560456, 0x04560456, 0x04560456, 0x04540454, 0x04540454
    .long 0x04540454, 0x04540454, 0x04520454, 0x04520452, 0x04520452, 0x04520452, 0x04500450, 0x04500450
    .long 0x04500450, 0x04500450, 0x044e0450, 0x044e044e, 0x044e044e, 0x044e044e, 0x044c044c, 0x044c044c
    .long 0x044c044c, 0x044c044c, 0x044a044c, 0x044a044a, 0x044a044a, 0x044a044a, 0x04480448, 0x04480448
    .long 0x04480448, 0x04480448, 0x04460448, 0x04460446, 0x04460446, 0x04460446, 0x04440444, 0x04440444
    .long 0x04440444, 0x04440444, 0x04420444, 0x04420442, 0x04420442, 0x04420442, 0x04400440, 0x04400440
    .long 0x04400440, 0x04400440, 0x043e0440, 0x043e043e, 0x043e043e, 0x043e043e, 0x043c043c, 0x043c043c
    .long 0x043c043c, 0x043c043c, 0x043a043c, 0x043a043a, 0x043a043a, 0x043a043a, 0x04380438, 0x04380438
    .long 0x04380438, 0x04380438, 0x04360438, 0x04360436, 0x04360436, 0x04360436, 0x04340434, 0x04340434
    .long 0x04340434, 0x04340434, 0x04320434, 0x04320432, 0x04320432, 0x04320432, 0x04300430, 0x04300430
    .long 0x04300430, 0x04300430, 0x042e0430, 0x042e042e, 0x042e042e, 0x042e042e, 0x042c042c, 0x042c042c
    .long 0x042c042c, 0x042c042c, 0x042a042c, 0x042a042a, 0x042a042a, 0x042a042a, 0x04280428, 0x04280428
    .long 0x04280428, 0x04280428, 0x04260428, 0x04260426, 0x04260426, 0x04260426, 0x04240424, 0x04240424
    .long 0x04240424, 0x04240424, 0x04220424, 0x04220422, 0x04220422, 0x04220422, 0x04200420, 0x04200420
    .long 0x04200420, 0x04200420, 0x041e0420, 0x041e041e, 0x041e041e, 0x041e041e, 0x041c041c, 0x041c041c
    .long 0x041c041c, 0x041c041c, 0x041a041c, 0x041a041a, 0x041a041a, 0x041a041a, 0x04180418, 0x04180418
    .long 0x04180418, 0x04180418, 0x04160418, 0x04160416, 0x04160416, 0x04160416, 0x04140414, 0x04140414
    .long 0x04140414, 0x04140414, 0x04120414, 0x04120412, 0x04120412, 0x04120412, 0x04100410, 0x04100410
    .long 0x04100410, 0x04100410, 0x040e0410, 0x040e040e, 0x040e040e, 0x040e040e, 0x040c040c, 0x040c040c
    .long 0x040c040c, 0x040c040c, 0x040a040c, 0x040a040a, 0x040a040a, 0x040a040a, 0x04080408, 0x04080408
    .long 0x04080408, 0x04080408, 0x04060408, 0x04060406, 0x04060406, 0x04060406, 0x04040404, 0x04040404
    .long 0x04040404, 0x04040404, 0x04020404, 0x04020402, 0x04020402, 0x04020402, 0x04000400, 0x04000400
    .long 0x04000400, 0x03fe0400, 0x03fe03fe, 0x03fc03fc, 0x03fc03fc, 0x03fa03fc, 0x03fa03fa, 0x03f803f8
    .long 0x03f803f8, 0x03f603f8, 0x03f603f6, 0x03f403f4, 0x03f403f4, 0x03f203f4, 0x03f203f2, 0x03f003f0
    .long 0x03f003f0, 0x03ee03f0, 0x03ee03ee, 0x03ec03ec, 0x03ec03ec, 0x03ea03ec, 0x03ea03ea, 0x03e803e8
    .long 0x03e803e8, 0x03e603e8, 0x03e603e6, 0x03e403e4, 0x03e403e4, 0x03e203e4, 0x03e203e2, 0x03e003e0
    .long 0x03e003e0, 0x03de03e0, 0x03de03de, 0x03dc03dc, 0x03dc03dc, 0x03da03dc, 0x03da03da, 0x03d803d8
    .long 0x03d803d8, 0x03d603d8, 0x03d603d6, 0x03d403d4, 0x03d403d4, 0x03d203d4, 0x03d203d2, 0x03d003d0
    .long 0x03d003d0, 0x03ce03d0, 0x03ce03ce, 0x03cc03cc, 0x03cc03cc, 0x03ca03cc, 0x03ca03ca, 0x03c803c8
    .long 0x03c803c8, 0x03c603c8, 0x03c603c6, 0x03c403c4, 0x03c403c4, 0x03c203c4, 0x03c203c2, 0x03c003c0
    .long 0x03c003c0, 0x03be03c0, 0x03be03be, 0x03bc03bc, 0x03bc03bc, 0x03ba03bc, 0x03ba03ba, 0x03b803b8
    .long 0x03b803b8, 0x03b603b8, 0x03b603b6, 0x03b403b4, 0x03b403b4, 0x03b203b4, 0x03b203b2, 0x03b003b0
    .long 0x03b003b0, 0x03ae03b0, 0x03ae03ae, 0x03ac03ac, 0x03ac03ac, 0x03aa03ac, 0x03aa03aa, 0x03a803a8
    .long 0x03a803a8, 0x03a603a8, 0x03a603a6, 0x03a403a4, 0x03a403a4, 0x03a203a4, 0x03a203a2, 0x03a003a0
    .long 0x03a003a0, 0x039e03a0, 0x039e039e, 0x039c039c, 0x039c039c, 0x039a039c, 0x039a039a, 0x03980398
    .long 0x03980398, 0x03960398, 0x03960396, 0x03940394, 0x03940394, 0x03920394, 0x03920392, 0x03900390
    .long 0x03900390, 0x038e0390, 0x038e038e, 0x038c038c, 0x038c038c, 0x038a038c, 0x038a038a, 0x03880388
    .long 0x03880388, 0x03860388, 0x03860386, 0x03840384, 0x03840384, 0x03820384, 0x03820382, 0x03800380
    .long 0x03800380, 0x037e0380, 0x037e037e, 0x037c037c, 0x037c037c, 0x037a037c, 0x037a037a, 0x03780378
    .long 0x03780378, 0x03760378, 0x03760376, 0x03740374, 0x03740374, 0x03720374, 0x03720372, 0x03700370
    .long 0x03700370, 0x036e0370, 0x036e036e, 0x036c036c, 0x036c036c, 0x036a036c, 0x036a036a, 0x03680368
    .long 0x03680368, 0x03660368, 0x03660366, 0x03640364, 0x03640364, 0x03620364, 0x03620362, 0x03600360
    .long 0x03600360, 0x035e0360, 0x035e035e, 0x035c035c, 0x035c035c, 0x035a035c, 0x035a035a, 0x03580358
    .long 0x03580358, 0x03560358, 0x03560356, 0x03540354, 0x03540354, 0x03520354, 0x03520352, 0x03500350
    .long 0x03500350, 0x034e0350, 0x034e034e, 0x034c034c, 0x034c034c, 0x034a034c, 0x034a034a, 0x03480348
    .long 0x03480348, 0x03460348, 0x03460346, 0x03440344, 0x03440344, 0x03420344, 0x03420342, 0x03400340
    .long 0x03400340, 0x033e0340, 0x033e033e, 0x033c033c, 0x033c033c, 0x033a033c, 0x033a033a, 0x03380338
    .long 0x03380338, 0x03360338, 0x03360336, 0x03340334, 0x03340334, 0x03320334, 0x03320332, 0x03300330
    .long 0x03300330, 0x032e0330, 0x032e032e, 0x032c032c, 0x032c032c, 0x032a032c, 0x032a032a, 0x03280328
    .long 0x03280328, 0x03260328, 0x03260326, 0x03240324, 0x03240324, 0x03220324, 0x03220322, 0x03200320
    .long 0x03200320, 0x031e0320, 0x031e031e, 0x031c031c, 0x031c031c, 0x031a031c, 0x031a031a, 0x03180318
    .long 0x03180318, 0x03160318, 0x03160316, 0x03140314, 0x03140314, 0x03120314, 0x03120312, 0x03100310
    .long 0x03100310, 0x030e0310, 0x030e030e, 0x030c030c, 0x030c030c, 0x030a030c, 0x030a030a, 0x03080308
    .long 0x03080308, 0x03060308, 0x03060306, 0x03040304, 0x03040304, 0x03020304, 0x03020302, 0x03000300
    .long 0x03000300, 0x02fc02fe, 0x02fc02fc, 0x02f802fa, 0x02f802f8, 0x02f402f6, 0x02f402f4, 0x02f002f2
    .long 0x02f002f0, 0x02ec02ee, 0x02ec02ec, 0x02e802ea, 0x02e802e8, 0x02e402e6, 0x02e402e4, 0x02e002e2
    .long 0x02e002e0, 0x02dc02de, 0x02dc02dc, 0x02d802da, 0x02d802d8, 0x02d402d6, 0x02d402d4, 0x02d002d2
    .long 0x02d002d0, 0x02cc02ce, 0x02cc02cc, 0x02c802ca, 0x02c802c8, 0x02c402c6, 0x02c402c4, 0x02c002c2
    .long 0x02c002c0, 0x02bc02be, 0x02bc02bc, 0x02b802ba, 0x02b802b8, 0x02b402b6, 0x02b402b4, 0x02b002b2
    .long 0x02b002b0, 0x02ac02ae, 0x02ac02ac, 0x02a802aa, 0x02a802a8, 0x02a402a6, 0x02a402a4, 0x02a002a2
    .long 0x02a002a0, 0x029c029e, 0x029c029c, 0x0298029a, 0x02980298, 0x02940296, 0x02940294, 0x02900292
    .long 0x02900290, 0x028c028e, 0x028c028c, 0x0288028a, 0x02880288, 0x02840286, 0x02840284, 0x02800282
    .long 0x02800280, 0x027c027e, 0x027c027c, 0x0278027a, 0x02780278, 0x02740276, 0x02740274, 0x02700272
    .long 0x02700270, 0x026c026e, 0x026c026c, 0x0268026a, 0x02680268, 0x02640266, 0x02640264, 0x02600262
    .long 0x02600260, 0x025c025e, 0x025c025c, 0x0258025a, 0x02580258, 0x02540256, 0x02540254, 0x02500252
    .long 0x02500250, 0x024c024e, 0x024c024c, 0x0248024a, 0x02480248, 0x02440246, 0x02440244, 0x02400242
    .long 0x02400240, 0x023c023e, 0x023c023c, 0x0238023a, 0x02380238, 0x02340236, 0x02340234, 0x02300232
    .long 0x02300230, 0x022c022e, 0x022c022c, 0x0228022a, 0x02280228, 0x02240226, 0x02240224, 0x02200222
    .long 0x02200220, 0x021c021e, 0x021c021c, 0x0218021a, 0x02180218, 0x02140216, 0x02140214, 0x02100212
    .long 0x02100210, 0x020c020e, 0x020c020c, 0x0208020a, 0x02080208, 0x02040206, 0x02040204, 0x02000202
    .long 0x01fe0200, 0x01fa01fc, 0x01f601f8, 0x01f201f4, 0x01ee01f0, 0x01ea01ec, 0x01e601e8, 0x01e201e4
    .long 0x01de01e0, 0x01da01dc, 0x01d601d8, 0x01d201d4, 0x01ce01d0, 0x01ca01cc, 0x01c601c8, 0x01c201c4
    .long 0x01be01c0, 0x01ba01bc, 0x01b601b8, 0x01b201b4, 0x01ae01b0, 0x01aa01ac, 0x01a601a8, 0x01a201a4
    .long 0x019e01a0, 0x019a019c, 0x01960198, 0x01920194, 0x018e0190, 0x018a018c, 0x01860188, 0x01820184
    .long 0x017e0180, 0x017a017c, 0x01760178, 0x01720174, 0x016e0170, 0x016a016c, 0x01660168, 0x01620164
    .long 0x015e0160, 0x015a015c, 0x01560158, 0x01520154, 0x014e0150, 0x014a014c, 0x01460148, 0x01420144
    .long 0x013e0140, 0x013a013c, 0x01360138, 0x01320134, 0x012e0130, 0x012a012c, 0x01260128, 0x01220124
    .long 0x011e0120, 0x011a011c, 0x01160118, 0x01120114, 0x010e0110, 0x010a010c, 0x01060108, 0x01020104
    .long 0x00fe0100, 0x00fa00fc, 0x00f600f8, 0x00f200f4, 0x00ee00f0, 0x00ea00ec, 0x00e600e8, 0x00e200e4
    .long 0x00de00e0, 0x00da00dc, 0x00d600d8, 0x00d200d4, 0x00ce00d0, 0x00ca00cc, 0x00c600c8, 0x00c200c4
    .long 0x00be00c0, 0x00ba00bc, 0x00b600b8, 0x00b200b4, 0x00ae00b0, 0x00aa00ac, 0x00a600a8, 0x00a200a4
    .long 0x009e00a0, 0x009a009c, 0x00960098, 0x00920094, 0x008e0090, 0x008a008c, 0x00860088, 0x00820084
    .long 0x007e0080, 0x007a007c, 0x00760078, 0x00720074, 0x006e0070, 0x006a006c, 0x00660068, 0x00620064
    .long 0x005e0060, 0x005a005c, 0x00560058, 0x00520054, 0x004e0050, 0x004a004c, 0x00460048, 0x00420044
    .long 0x003e0040, 0x003a003c, 0x00360038, 0x00320034, 0x002e0030, 0x002a002c, 0x00260028, 0x00220024
    .long 0x001e0020, 0x001a001c, 0x00160018, 0x00120014, 0x000e0010, 0x000a000c, 0x00060008, 0x00020004
    .long 0x06000000, 0x06000600, 0x06000600, 0x06000600, 0x06000600, 0x06000600, 0x06000600, 0x06000600
    .long 0x06000600, 0x06000600, 0x06000600, 0x06000600, 0x06000600, 0x06000600, 0x06000600, 0x06000600
    .long 0x06000600, 0x06000600, 0x06000600, 0x06000600, 0x06000600, 0x06000600, 0x06000600, 0x06000600
    .long 0x06000600, 0x06000600, 0x06000600, 0x06000600, 0x06000600, 0x06000600, 0x06000600, 0x06000600
    .long 0x06000600, 0x06000600, 0x06000600, 0x06000600, 0x06000600, 0x06000600, 0x06000600, 0x06000600
.size Lkg_tab, 6400
.globl cm1_kernel
.p2align 8
.type cm1_kernel,@function
cm1_kernel:
    s_mov_b32 s32, 0x2800000
    s_mov_b32 s33, 0x800000
    s_mov_b32 s52, 0x2040000
    s_mov_b32 s53, 0
    s_mov_b32 s62, 0x2048000
    s_mov_b32 s60, 0x2400000
    s_mov_b32 s61, 0x2000000
    s_mov_b32 s63, 0x2050000
    s_branch Lg1_body
.globl cm2_kernel
.p2align 8
.type cm2_kernel,@function
cm2_kernel:
    s_mov_b32 s32, 0x3000000
    s_mov_b32 s33, 0x1000000
    s_mov_b32 s52, 0x2050000
    s_mov_b32 s53, 1
    s_mov_b32 s62, 0x2058000
    s_mov_b32 s60, 0x2c00000
    s_mov_b32 s61, 0x2010000
    s_mov_b32 s63, 0x2060000
    s_branch Lg1_body
    .p2align 8
Lg1_body:
    s_cmp_ge_u32 s2, 256
    s_cbranch_scc1 Lg1_end
    s_load_dwordx2 s[4:5], s[0:1], 112
    s_load_dwordx2 s[64:65], s[0:1], 48
    s_load_dwordx2 s[6:7], s[0:1], 72
    s_load_dwordx4 s[72:75], s[0:1], 88
    v_and_b32 v1, 63, v0
    v_lshrrev_b32 v2, 6, v0
    s_nop 0
    v_readfirstlane_b32 s36, v2
    s_cmp_ge_u32 s36, 4
    s_cbranch_scc1 Lcm_conv
    v_lshlrev_b32 v3, 4, v1
    s_mov_b32 s46, s62
    s_and_b32 s12, s2, 7
    s_lshr_b32 s13, s2, 3
    s_lshl_b32 s54, s12, 2
    s_and_b32 s55, s13, 3
    s_add_u32 s54, s54, s55
    s_lshr_b32 s55, s13, 2
    s_bfe_u32 s56, s36, 0x10001
    s_and_b32 s57, s36, 1
    s_lshl_b32 s76, s55, 1
    s_add_u32 s76, s76, s56
    s_lshl_b32 s77, s54, 1
    s_add_u32 s77, s77, s57
    s_mul_i32 s78, s36, 14336
    s_mul_i32 s79, s55, 7
    s_lshr_b32 s79, s79, 2
    s_lshl_b32 s79, s79, 10
    s_mul_i32 s80, s76, 114688
    s_add_u32 s80, s80, s78
    s_add_u32 s80, s80, 27262976
    s_xor_b32 s81, s76, 1
    s_mul_i32 s81, s81, 114688
    s_add_u32 s81, s81, s78
    s_add_u32 s81, s81, 27262976
    s_lshr_b32 s82, s36, 2
    s_lshl_b32 s83, s82, 4
    v_xor_b32 v31, s83, v1
    v_lshlrev_b32 v31, 4, v31
    v_lshrrev_b32 v5, 5, v1
    v_bfe_u32 v10, v1, 4, 1
    s_mov_b32 s28, 0x3b000000
    s_mov_b32 s29, 0x3727c5ac
    s_cmp_ge_u32 s2, 224
    s_cbranch_scc1 Lcm_idle_m
    s_and_b32 s12, s2, 7
    s_lshr_b32 s13, s2, 3
    s_lshr_b32 s14, s12, 1
    s_lshl_b32 s14, s14, 2
    s_and_b32 s15, s13, 3
    s_add_u32 s14, s14, s15
    s_and_b32 s15, s12, 1
    s_mul_i32 s15, s15, 7
    s_lshr_b32 s16, s13, 2
    s_add_u32 s15, s15, s16
    s_mov_b32 s39, s16
    s_and_b32 s3, s36, 3
    s_lshl_b32 s16, s15, 2
    s_add_u32 s16, s16, s3
    v_lshrrev_b32 v5, 5, v1
    v_lshlrev_b32 v6, 3, v5
    v_lshlrev_b32 v7, 4, v5
    s_lshl_b32 s26, s16, 6
    s_lshl_b32 s27, s16, 7
    s_add_u32 s27, s27, 33685504
    v_bfe_u32 v10, v1, 4, 1
    s_lshl_b32 s37, s3, 12
    v_add_u32 v24, s37, v3
    v_and_b32 v25, 31, v1
    v_lshlrev_b32 v25, 3, v25
    s_lshl_b32 s47, s14, 10
    s_add_u32 s46, s46, s47
    s_lshl_b32 s47, s3, 2
    s_add_u32 s47, s47, 131072
    v_mov_b32 v29, s47
    v_mov_b32 v28, 0
    ds_write_b32 v29, v28
    s_mul_i32 s34, s14, 458752
    s_lshl_b32 s35, s16, 11
    s_add_u32 s34, s34, s35
    s_add_u32 s34, s34, s33
    s_mov_b32 s28, 0x3b000000
    s_mov_b32 s29, 0x3727c5ac
    s_mov_b32 s30, 0xbdd2d3e8
    s_mov_b32 s31, 0xbdd2d3e8
    v_mov_b32 v26, 0xc0135761
    v_mov_b32 v27, 0xc0135761
    s_waitcnt lgkmcnt(0)
    s_mov_b32 s8, s4
    s_mov_b32 s9, s5
    s_mov_b32 s10, 0x10000000
    s_mov_b32 s11, 0x00020000
    s_mov_b32 s20, s6
    s_mov_b32 s21, s7
    s_mov_b32 s22, 0xe00
    s_mov_b32 s23, 0x00020000
    s_lshl_b32 s17, s16, 15
    s_add_u32 s17, s17, 25165824
    s_add_u32 s44, s3, 0
    s_and_b32 s44, s44, 3
    s_lshl_b32 s48, s44, 11
    s_lshl_b32 s44, s44, 10
    s_add_u32 s40, s17, s44
    s_add_u32 s44, s3, 1
    s_and_b32 s44, s44, 3
    s_lshl_b32 s49, s44, 11
    s_lshl_b32 s44, s44, 10
    s_add_u32 s41, s17, s44
    s_add_u32 s44, s3, 2
    s_and_b32 s44, s44, 3
    s_lshl_b32 s50, s44, 11
    s_lshl_b32 s44, s44, 10
    s_add_u32 s42, s17, s44
    s_add_u32 s44, s3, 3
    s_and_b32 s44, s44, 3
    s_lshl_b32 s51, s44, 11
    s_lshl_b32 s44, s44, 10
    s_add_u32 s43, s17, s44
    v_bfe_u32 v8, v1, 2, 2
    v_and_b32 v9, 3, v1
    v_lshlrev_b32 v11, 10, v5
    v_lshl_add_u32 v11, v8, 7, v11
    v_lshl_add_u32 v11, v10, 5, v11
    v_lshl_add_u32 v11, v9, 3, v11
    v_lshrrev_b32 v8, 1, v8
    v_lshl_add_u32 v20, v8, 6, v11
    v_xor_b32 v8, 1, v8
    v_lshl_add_u32 v21, v8, 6, v11
    v_add_u32 v30, 131072, v25
    v_add_u32 v12, s48, v20
    v_add_u32 v13, s48, v21
    v_add_u32 v14, s49, v20
    v_add_u32 v15, s49, v21
    v_add_u32 v16, s50, v20
    v_add_u32 v17, s50, v21
    v_add_u32 v18, s51, v20
    v_add_u32 v19, s51, v21
    v_mov_b32 v40, v12
    s_cmp_ge_u32 s2, 13
    s_cbranch_scc1 Lcm_nc1
    v_lshlrev_b32 v12, 4, v0
    v_mov_b32 v16, 0
    v_mov_b32 v17, 0
    v_mov_b32 v18, 0
    v_mov_b32 v19, 0
    s_lshl_b32 s44, s2, 12
    s_add_u32 s44, s44, s63
    buffer_store_dwordx4 v[16:19], v12, s[8:11], s44 offen sc1
Lcm_nc1:
    v_add_u32 v12, s48, v20
    v_add_u32 v13, s48, v21
    v_add_u32 v14, s49, v20
    v_add_u32 v15, s49, v21
    v_add_u32 v16, s50, v20
    v_add_u32 v17, s50, v21
    v_add_u32 v18, s51, v20
    v_add_u32 v19, s51, v21
    s_barrier
    s_add_u32 s45, s39, 0
    s_and_b32 s45, s45, 7
    s_lshl_b32 s45, s45, 12
    s_add_u32 s25, s40, s45
    buffer_load_dwordx4 a[0:3], v3, s[8:11], s25 offen
    s_add_u32 s25, s41, s45
    buffer_load_dwordx4 a[4:7], v3, s[8:11], s25 offen
    s_add_u32 s25, s42, s45
    buffer_load_dwordx4 a[8:11], v3, s[8:11], s25 offen
    s_add_u32 s25, s43, s45
    buffer_load_dwordx4 a[12:15], v3, s[8:11], s25 offen
    s_add_u32 s45, s39, 1
    s_and_b32 s45, s45, 7
    s_lshl_b32 s45, s45, 12
    s_add_u32 s25, s40, s45
    buffer_load_dwordx4 a[16:19], v3, s[8:11], s25 offen
    s_add_u32 s25, s41, s45
    buffer_load_dwordx4 a[20:23], v3, s[8:11], s25 offen
    s_add_u32 s25, s42, s45
    buffer_load_dwordx4 a[24:27], v3, s[8:11], s25 offen
    s_add_u32 s25, s43, s45
    buffer_load_dwordx4 a[28:31], v3, s[8:11], s25 offen
    s_add_u32 s45, s39, 2
    s_and_b32 s45, s45, 7
    s_lshl_b32 s45, s45, 12
    s_add_u32 s25, s40, s45
    buffer_load_dwordx4 a[32:35], v3, s[8:11], s25 offen
    s_add_u32 s25, s41, s45
    buffer_load_dwordx4 a[36:39], v3, s[8:11], s25 offen
    s_add_u32 s25, s42, s45
    buffer_load_dwordx4 a[40:43], v3, s[8:11], s25 offen
    s_add_u32 s25, s43, s45
    buffer_load_dwordx4 a[44:47], v3, s[8:11], s25 offen
    s_add_u32 s45, s39, 3
    s_and_b32 s45, s45, 7
    s_lshl_b32 s45, s45, 12
    s_add_u32 s25, s40, s45
    buffer_load_dwordx4 a[48:51], v3, s[8:11], s25 offen
    s_add_u32 s25, s41, s45
    buffer_load_dwordx4 a[52:55], v3, s[8:11], s25 offen
    s_add_u32 s25, s42, s45
    buffer_load_dwordx4 a[56:59], v3, s[8:11], s25 offen
    s_add_u32 s25, s43, s45
    buffer_load_dwordx4 a[60:63], v3, s[8:11], s25 offen
    s_add_u32 s45, s39, 4
    s_and_b32 s45, s45, 7
    s_lshl_b32 s45, s45, 12
    s_add_u32 s25, s40, s45
    buffer_load_dwordx4 a[64:67], v3, s[8:11], s25 offen
    s_add_u32 s25, s41, s45
    buffer_load_dwordx4 a[68:71], v3, s[8:11], s25 offen
    s_add_u32 s25, s42, s45
    buffer_load_dwordx4 a[72:75], v3, s[8:11], s25 offen
    s_add_u32 s25, s43, s45
    buffer_load_dwordx4 a[76:79], v3, s[8:11], s25 offen
    s_add_u32 s45, s39, 5
    s_and_b32 s45, s45, 7
    s_lshl_b32 s45, s45, 12
    s_add_u32 s25, s40, s45
    buffer_load_dwordx4 a[80:83], v3, s[8:11], s25 offen
    s_add_u32 s25, s41, s45
    buffer_load_dwordx4 a[84:87], v3, s[8:11], s25 offen
    s_add_u32 s25, s42, s45
    buffer_load_dwordx4 a[88:91], v3, s[8:11], s25 offen
    s_add_u32 s25, s43, s45
    buffer_load_dwordx4 a[92:95], v3, s[8:11], s25 offen
    s_add_u32 s45, s39, 6
    s_and_b32 s45, s45, 7
    s_lshl_b32 s45, s45, 12
    s_add_u32 s25, s40, s45
    buffer_load_dwordx4 a[96:99], v3, s[8:11], s25 offen
    s_add_u32 s25, s41, s45
    buffer_load_dwordx4 a[100:103], v3, s[8:11], s25 offen
    s_add_u32 s25, s42, s45
    buffer_load_dwordx4 a[104:107], v3, s[8:11], s25 offen
    s_add_u32 s25, s43, s45
    buffer_load_dwordx4 a[108:111], v3, s[8:11], s25 offen
    s_add_u32 s45, s39, 7
    s_and_b32 s45, s45, 7
    s_lshl_b32 s45, s45, 12
    s_add_u32 s25, s40, s45
    buffer_load_dwordx4 a[112:115], v3, s[8:11], s25 offen
    s_add_u32 s25, s41, s45
    buffer_load_dwordx4 a[116:119], v3, s[8:11], s25 offen
    s_add_u32 s25, s42, s45
    buffer_load_dwordx4 a[120:123], v3, s[8:11], s25 offen
    s_add_u32 s25, s43, s45
    buffer_load_dwordx4 a[124:127], v3, s[8:11], s25 offen
    s_barrier
    s_barrier
    s_barrier
    s_waitcnt vmcnt(0)
    s_barrier
    s_barrier
    ds_read_b64_tr_b16 v[40:41], v12 offset:0
    ds_read_b64_tr_b16 v[42:43], v12 offset:512
    ds_read_b64_tr_b16 v[44:45], v13 offset:0
    ds_read_b64_tr_b16 v[46:47], v13 offset:512
    ds_read_b64_tr_b16 v[48:49], v14 offset:0
    ds_read_b64_tr_b16 v[50:51], v14 offset:512
    ds_read_b64_tr_b16 v[52:53], v15 offset:0
    ds_read_b64_tr_b16 v[54:55], v15 offset:512
    s_waitcnt lgkmcnt(6)
    v_mfma_f32_32x32x16_bf16 v[64:79], a[0:3], v[40:43], 0
    ds_read_b64_tr_b16 v[56:57], v16 offset:0
    ds_read_b64_tr_b16 v[58:59], v16 offset:512
    s_waitcnt lgkmcnt(6)
    v_mfma_f32_32x32x16_bf16 v[80:95], a[0:3], v[44:47], 0
    ds_read_b64_tr_b16 v[60:61], v17 offset:0
    ds_read_b64_tr_b16 v[62:63], v17 offset:512
    s_waitcnt lgkmcnt(6)
    v_mfma_f32_32x32x16_bf16 v[64:79], a[4:7], v[48:51], v[64:79]
    ds_read_b64_tr_b16 v[40:41], v18 offset:0
    ds_read_b64_tr_b16 v[42:43], v18 offset:512
    s_waitcnt lgkmcnt(6)
    v_mfma_f32_32x32x16_bf16 v[80:95], a[4:7], v[52:55], v[80:95]
    ds_read_b64_tr_b16 v[44:45], v19 offset:0
    ds_read_b64_tr_b16 v[46:47], v19 offset:512
    s_waitcnt lgkmcnt(6)
    v_mfma_f32_32x32x16_bf16 v[64:79], a[8:11], v[56:59], v[64:79]
    s_barrier
    ds_read_b64_tr_b16 v[48:49], v12 offset:8192
    ds_read_b64_tr_b16 v[50:51], v12 offset:8704
    s_waitcnt lgkmcnt(6)
    v_mfma_f32_32x32x16_bf16 v[80:95], a[8:11], v[60:63], v[80:95]
    ds_read_b64_tr_b16 v[52:53], v13 offset:8192
    ds_read_b64_tr_b16 v[54:55], v13 offset:8704
    s_waitcnt lgkmcnt(6)
    v_mfma_f32_32x32x16_bf16 v[64:79], a[12:15], v[40:43], v[64:79]
    ds_read_b64_tr_b16 v[56:57], v14 offset:8192
    ds_read_b64_tr_b16 v[58:59], v14 offset:8704
    s_waitcnt lgkmcnt(6)
    v_mfma_f32_32x32x16_bf16 v[80:95], a[12:15], v[44:47], v[80:95]
    ds_read_b64_tr_b16 v[60:61], v15 offset:8192
    ds_read_b64_tr_b16 v[62:63], v15 offset:8704
    s_waitcnt lgkmcnt(6)
    v_mfma_f32_32x32x16_bf16 v[64:79], a[16:19], v[48:51], v[64:79]
    ds_read_b64_tr_b16 v[40:41], v16 offset:8192
    ds_read_b64_tr_b16 v[42:43], v16 offset:8704
    s_waitcnt lgkmcnt(6)
    v_mfma_f32_32x32x16_bf16 v[80:95], a[16:19], v[52:55], v[80:95]
    ds_read_b64_tr_b16 v[44:45], v17 offset:8192
    ds_read_b64_tr_b16 v[46:47], v17 offset:8704
    s_waitcnt lgkmcnt(6)
    v_mfma_f32_32x32x16_bf16 v[64:79], a[20:23], v[56:59], v[64:79]
    ds_read_b64_tr_b16 v[48:49], v18 offset:8192
    ds_read_b64_tr_b16 v[50:51], v18 offset:8704
    s_waitcnt lgkmcnt(6)
    v_mfma_f32_32x32x16_bf16 v[80:95], a[20:23], v[60:63], v[80:95]
    ds_read_b64_tr_b16 v[52:53], v19 offset:8192
    ds_read_b64_tr_b16 v[54:55], v19 offset:8704
    s_waitcnt lgkmcnt(6)
    v_mfma_f32_32x32x16_bf16 v[64:79], a[24:27], v[40:43], v[64:79]
    s_barrier
    ds_read_b64_tr_b16 v[56:57], v12 offset:16384
    ds_read_b64_tr_b16 v[58:59], v12 offset:16896
    s_waitcnt lgkmcnt(6)
    v_mfma_f32_32x32x16_bf16 v[80:95], a[24:27], v[44:47], v[80:95]
    ds_read_b64_tr_b16 v[60:61], v13 offset:16384
    ds_read_b64_tr_b16 v[62:63], v13 offset:16896
    s_waitcnt lgkmcnt(6)
    v_mfma_f32_32x32x16_bf16 v[64:79], a[28:31], v[48:51], v[64:79]
    ds_read_b64_tr_b16 v[40:41], v14 offset:16384
    ds_read_b64_tr_b16 v[42:43], v14 offset:16896
    s_waitcnt lgkmcnt(6)
    v_mfma_f32_32x32x16_bf16 v[80:95], a[28:31], v[52:55], v[80:95]
    ds_read_b64_tr_b16 v[44:45], v15 offset:16384
    ds_read_b64_tr_b16 v[46:47], v15 offset:16896
    s_waitcnt lgkmcnt(6)
    v_mfma_f32_32x32x16_bf16 v[64:79], a[32:35], v[56:59], v[64:79]
    ds_read_b64_tr_b16 v[48:49], v16 offset:16384
    ds_read_b64_tr_b16 v[50:51], v16 offset:16896
    s_waitcnt lgkmcnt(6)
    v_mfma_f32_32x32x16_bf16 v[80:95], a[32:35], v[60:63], v[80:95]
    ds_read_b64_tr_b16 v[52:53], v17 offset:16384
    ds_read_b64_tr_b16 v[54:55], v17 offset:16896
    s_waitcnt lgkmcnt(6)
    v_mfma_f32_32x32x16_bf16 v[64:79], a[36:39], v[40:43], v[64:79]
    ds_read_b64_tr_b16 v[56:57], v18 offset:16384
    ds_read_b64_tr_b16 v[58:59], v18 offset:16896
    s_waitcnt lgkmcnt(6)
    v_mfma_f32_32x32x16_bf16 v[80:95], a[36:39], v[44:47], v[80:95]
    ds_read_b64_tr_b16 v[60:61], v19 offset:16384
    ds_read_b64_tr_b16 v[62:63], v19 offset:16896
    s_waitcnt lgkmcnt(6)
    v_mfma_f32_32x32x16_bf16 v[64:79], a[40:43], v[48:51], v[64:79]
    s_barrier
    ds_read_b64_tr_b16 v[40:41], v12 offset:24576
    ds_read_b64_tr_b16 v[42:43], v12 offset:25088
    s_waitcnt lgkmcnt(6)
    v_mfma_f32_32x32x16_bf16 v[80:95], a[40:43], v[52:55], v[80:95]
    ds_read_b64_tr_b16 v[44:45], v13 offset:24576
    ds_read_b64_tr_b16 v[46:47], v13 offset:25088
    s_waitcnt lgkmcnt(6)
    v_mfma_f32_32x32x16_bf16 v[64:79], a[44:47], v[56:59], v[64:79]
    ds_read_b64_tr_b16 v[48:49], v14 offset:24576
    ds_read_b64_tr_b16 v[50:51], v14 offset:25088
    s_waitcnt lgkmcnt(6)
    v_mfma_f32_32x32x16_bf16 v[80:95], a[44:47], v[60:63], v[80:95]
    ds_read_b64_tr_b16 v[52:53], v15 offset:24576
    ds_read_b64_tr_b16 v[54:55], v15 offset:25088
    s_waitcnt lgkmcnt(6)
    v_mfma_f32_32x32x16_bf16 v[64:79], a[48:51], v[40:43], v[64:79]
    ds_read_b64_tr_b16 v[56:57], v16 offset:24576
    ds_read_b64_tr_b16 v[58:59], v16 offset:25088
    s_waitcnt lgkmcnt(6)
    v_mfma_f32_32x32x16_bf16 v[80:95], a[48:51], v[44:47], v[80:95]
    ds_read_b64_tr_b16 v[60:61], v17 offset:24576
    ds_read_b64_tr_b16 v[62:63], v17 offset:25088
    s_waitcnt lgkmcnt(6)
    v_mfma_f32_32x32x16_bf16 v[64:79], a[52:55], v[48:51], v[64:79]
    ds_read_b64_tr_b16 v[40:41], v18 offset:24576
    ds_read_b64_tr_b16 v[42:43], v18 offset:25088
    s_waitcnt lgkmcnt(6)
    v_mfma_f32_32x32x16_bf16 v[80:95], a[52:55], v[52:55], v[80:95]
    ds_read_b64_tr_b16 v[44:45], v19 offset:24576
    ds_read_b64_tr_b16 v[46:47], v19 offset:25088
    s_waitcnt lgkmcnt(6)
    v_mfma_f32_32x32x16_bf16 v[64:79], a[56:59], v[56:59], v[64:79]
    s_barrier
    ds_read_b64_tr_b16 v[48:49], v12 offset:32768
    ds_read_b64_tr_b16 v[50:51], v12 offset:33280
    s_waitcnt lgkmcnt(6)
    v_mfma_f32_32x32x16_bf16 v[80:95], a[56:59], v[60:63], v[80:95]
    ds_read_b64_tr_b16 v[52:53], v13 offset:32768
    ds_read_b64_tr_b16 v[54:55], v13 offset:33280
    s_waitcnt lgkmcnt(6)
    v_mfma_f32_32x32x16_bf16 v[64:79], a[60:63], v[40:43], v[64:79]
    ds_read_b64_tr_b16 v[56:57], v14 offset:32768
    ds_read_b64_tr_b16 v[58:59], v14 offset:33280
    s_waitcnt lgkmcnt(6)
    v_mfma_f32_32x32x16_bf16 v[80:95], a[60:63], v[44:47], v[80:95]
    ds_read_b64_tr_b16 v[60:61], v15 offset:32768
    ds_read_b64_tr_b16 v[62:63], v15 offset:33280
    s_waitcnt lgkmcnt(6)
    v_mfma_f32_32x32x16_bf16 v[64:79], a[64:67], v[48:51], v[64:79]
    ds_read_b64_tr_b16 v[40:41], v16 offset:32768
    ds_read_b64_tr_b16 v[42:43], v16 offset:33280
    s_waitcnt lgkmcnt(6)
    v_mfma_f32_32x32x16_bf16 v[80:95], a[64:67], v[52:55], v[80:95]
    ds_read_b64_tr_b16 v[44:45], v17 offset:32768
    ds_read_b64_tr_b16 v[46:47], v17 offset:33280
    s_waitcnt lgkmcnt(6)
    v_mfma_f32_32x32x16_bf16 v[64:79], a[68:71], v[56:59], v[64:79]
    ds_read_b64_tr_b16 v[48:49], v18 offset:32768
    ds_read_b64_tr_b16 v[50:51], v18 offset:33280
    s_waitcnt lgkmcnt(6)
    v_mfma_f32_32x32x16_bf16 v[80:95], a[68:71], v[60:63], v[80:95]
    ds_read_b64_tr_b16 v[52:53], v19 offset:32768
    ds_read_b64_tr_b16 v[54:55], v19 offset:33280
    s_waitcnt lgkmcnt(6)
    v_mfma_f32_32x32x16_bf16 v[64:79], a[72:75], v[40:43], v[64:79]
    s_barrier
    ds_read_b64_tr_b16 v[56:57], v12 offset:40960
    ds_read_b64_tr_b16 v[58:59], v12 offset:41472
    s_waitcnt lgkmcnt(6)
    v_mfma_f32_32x32x16_bf16 v[80:95], a[72:75], v[44:47], v[80:95]
    ds_read_b64_tr_b16 v[60:61], v13 offset:40960
    ds_read_b64_tr_b16 v[62:63], v13 offset:41472
    s_waitcnt lgkmcnt(6)
    v_mfma_f32_32x32x16_bf16 v[64:79], a[76:79], v[48:51], v[64:79]
    ds_read_b64_tr_b16 v[40:41], v14 offset:40960
    ds_read_b64_tr_b16 v[42:43], v14 offset:41472
    s_waitcnt lgkmcnt(6)
    v_mfma_f32_32x32x16_bf16 v[80:95], a[76:79], v[52:55], v[80:95]
    ds_read_b64_tr_b16 v[44:45], v15 offset:40960
    ds_read_b64_tr_b16 v[46:47], v15 offset:41472
    s_waitcnt lgkmcnt(6)
    v_mfma_f32_32x32x16_bf16 v[64:79], a[80:83], v[56:59], v[64:79]
    ds_read_b64_tr_b16 v[48:49], v16 offset:40960
    ds_read_b64_tr_b16 v[50:51], v16 offset:41472
    s_waitcnt lgkmcnt(6)
    v_mfma_f32_32x32x16_bf16 v[80:95], a[80:83], v[60:63], v[80:95]
    ds_read_b64_tr_b16 v[52:53], v17 offset:40960
    ds_read_b64_tr_b16 v[54:55], v17 offset:41472
    s_waitcnt lgkmcnt(6)
    v_mfma_f32_32x32x16_bf16 v[64:79], a[84:87], v[40:43], v[64:79]
    ds_read_b64_tr_b16 v[56:57], v18 offset:40960
    ds_read_b64_tr_b16 v[58:59], v18 offset:41472
    s_waitcnt lgkmcnt(6)
    v_mfma_f32_32x32x16_bf16 v[80:95], a[84:87], v[44:47], v[80:95]
    ds_read_b64_tr_b16 v[60:61], v19 offset:40960
    ds_read_b64_tr_b16 v[62:63], v19 offset:41472
    s_waitcnt lgkmcnt(6)
    v_mfma_f32_32x32x16_bf16 v[64:79], a[88:91], v[48:51], v[64:79]
    s_barrier
    ds_read_b64_tr_b16 v[40:41], v12 offset:49152
    ds_read_b64_tr_b16 v[42:43], v12 offset:49664
    s_waitcnt lgkmcnt(6)
    v_mfma_f32_32x32x16_bf16 v[80:95], a[88:91], v[52:55], v[80:95]
    ds_read_b64_tr_b16 v[44:45], v13 offset:49152
    ds_read_b64_tr_b16 v[46:47], v13 offset:49664
    s_waitcnt lgkmcnt(6)
    v_mfma_f32_32x32x16_bf16 v[64:79], a[92:95], v[56:59], v[64:79]
    ds_read_b64_tr_b16 v[48:49], v14 offset:49152
    ds_read_b64_tr_b16 v[50:51], v14 offset:49664
    s_waitcnt lgkmcnt(6)
    v_mfma_f32_32x32x16_bf16 v[80:95], a[92:95], v[60:63], v[80:95]
    ds_read_b64_tr_b16 v[52:53], v15 offset:49152
    ds_read_b64_tr_b16 v[54:55], v15 offset:49664
    s_waitcnt lgkmcnt(6)
    v_mfma_f32_32x32x16_bf16 v[64:79], a[96:99], v[40:43], v[64:79]
    ds_read_b64_tr_b16 v[56:57], v16 offset:49152
    ds_read_b64_tr_b16 v[58:59], v16 offset:49664
    s_waitcnt lgkmcnt(6)
    v_mfma_f32_32x32x16_bf16 v[80:95], a[96:99], v[44:47], v[80:95]
    ds_read_b64_tr_b16 v[60:61], v17 offset:49152
    ds_read_b64_tr_b16 v[62:63], v17 offset:49664
    s_waitcnt lgkmcnt(6)
    v_mfma_f32_32x32x16_bf16 v[64:79], a[100:103], v[48:51], v[64:79]
    ds_read_b64_tr_b16 v[40:41], v18 offset:49152
    ds_read_b64_tr_b16 v[42:43], v18 offset:49664
    s_waitcnt lgkmcnt(6)
    v_mfma_f32_32x32x16_bf16 v[80:95], a[100:103], v[52:55], v[80:95]
    ds_read_b64_tr_b16 v[44:45], v19 offset:49152
    ds_read_b64_tr_b16 v[46:47], v19 offset:49664
    s_waitcnt lgkmcnt(6)
    v_mfma_f32_32x32x16_bf16 v[64:79], a[104:107], v[56:59], v[64:79]
    s_barrier
    ds_read_b64_tr_b16 v[48:49], v12 offset:57344
    ds_read_b64_tr_b16 v[50:51], v12 offset:57856
    s_waitcnt lgkmcnt(6)
    v_mfma_f32_32x32x16_bf16 v[80:95], a[104:107], v[60:63], v[80:95]
    ds_read_b64_tr_b16 v[52:53], v13 offset:57344
    ds_read_b64_tr_b16 v[54:55], v13 offset:57856
    s_waitcnt lgkmcnt(6)
    v_mfma_f32_32x32x16_bf16 v[64:79], a[108:111], v[40:43], v[64:79]
    ds_read_b64_tr_b16 v[56:57], v14 offset:57344
    ds_read_b64_tr_b16 v[58:59], v14 offset:57856
    s_waitcnt lgkmcnt(6)
    v_mfma_f32_32x32x16_bf16 v[80:95], a[108:111], v[44:47], v[80:95]
    ds_read_b64_tr_b16 v[60:61], v15 offset:57344
    ds_read_b64_tr_b16 v[62:63], v15 offset:57856
    s_waitcnt lgkmcnt(6)
    v_mfma_f32_32x32x16_bf16 v[64:79], a[112:115], v[48:51], v[64:79]
    ds_read_b64_tr_b16 v[40:41], v16 offset:57344
    ds_read_b64_tr_b16 v[42:43], v16 offset:57856
    s_waitcnt lgkmcnt(6)
    v_mfma_f32_32x32x16_bf16 v[80:95], a[112:115], v[52:55], v[80:95]
    ds_read_b64_tr_b16 v[44:45], v17 offset:57344
    ds_read_b64_tr_b16 v[46:47], v17 offset:57856
    s_waitcnt lgkmcnt(6)
    v_mfma_f32_32x32x16_bf16 v[64:79], a[116:119], v[56:59], v[64:79]
    ds_read_b64_tr_b16 v[48:49], v18 offset:57344
    ds_read_b64_tr_b16 v[50:51], v18 offset:57856
    s_waitcnt lgkmcnt(6)
    v_mfma_f32_32x32x16_bf16 v[80:95], a[116:119], v[60:63], v[80:95]
    ds_read_b64_tr_b16 v[52:53], v19 offset:57344
    ds_read_b64_tr_b16 v[54:55], v19 offset:57856
    s_waitcnt lgkmcnt(6)
    v_mfma_f32_32x32x16_bf16 v[64:79], a[120:123], v[40:43], v[64:79]
    v_add_u32 v12, 0x10000, v12
    v_add_u32 v13, 0x10000, v13
    v_add_u32 v14, 0x10000, v14
    v_add_u32 v15, 0x10000, v15
    v_add_u32 v16, 0x10000, v16
    v_add_u32 v17, 0x10000, v17
    v_add_u32 v18, 0x10000, v18
    v_add_u32 v19, 0x10000, v19
    s_barrier
    ds_read_b64_tr_b16 v[56:57], v12 offset:0
    ds_read_b64_tr_b16 v[58:59], v12 offset:512
    s_waitcnt lgkmcnt(6)
    v_mfma_f32_32x32x16_bf16 v[80:95], a[120:123], v[44:47], v[80:95]
    ds_read_b64_tr_b16 v[60:61], v13 offset:0
    ds_read_b64_tr_b16 v[62:63], v13 offset:512
    s_waitcnt lgkmcnt(6)
    v_mfma_f32_32x32x16_bf16 v[64:79], a[124:127], v[48:51], v[64:79]
    ds_read_b64_tr_b16 v[40:41], v14 offset:0
    ds_read_b64_tr_b16 v[42:43], v14 offset:512
    s_waitcnt lgkmcnt(6)
    v_mfma_f32_32x32x16_bf16 v[80:95], a[124:127], v[52:55], v[80:95]
    ds_read_b64_tr_b16 v[44:45], v15 offset:0
    ds_read_b64_tr_b16 v[46:47], v15 offset:512
    s_barrier
    s_waitcnt lgkmcnt(6)
    v_mfma_f32_32x32x16_bf16 v[96:111], a[0:3], v[56:59], 0
    ds_read_b64_tr_b16 v[48:49], v16 offset:0
    ds_read_b64_tr_b16 v[50:51], v16 offset:512
    s_waitcnt lgkmcnt(6)
    v_mfma_f32_32x32x16_bf16 v[112:127], a[0:3], v[60:63], 0
    ds_read_b64_tr_b16 v[52:53], v17 offset:0
    ds_read_b64_tr_b16 v[54:55], v17 offset:512
    s_waitcnt lgkmcnt(6)
    v_mfma_f32_32x32x16_bf16 v[96:111], a[4:7], v[40:43], v[96:111]
    ds_read_b64_tr_b16 v[56:57], v18 offset:0
    ds_read_b64_tr_b16 v[58:59], v18 offset:512
    s_waitcnt lgkmcnt(6)
    v_mfma_f32_32x32x16_bf16 v[112:127], a[4:7], v[44:47], v[112:127]
    ds_read_b64_tr_b16 v[60:61], v19 offset:0
    ds_read_b64_tr_b16 v[62:63], v19 offset:512
    s_waitcnt lgkmcnt(6)
    v_mfma_f32_32x32x16_bf16 v[96:111], a[8:11], v[48:51], v[96:111]
    ds_read_b64_tr_b16 v[40:41], v12 offset:8192
    ds_read_b64_tr_b16 v[42:43], v12 offset:8704
    ds_write_b128 v24, v[64:67] offset:0
    s_waitcnt lgkmcnt(7)
    v_mfma_f32_32x32x16_bf16 v[112:127], a[8:11], v[52:55], v[112:127]
    ds_read_b64_tr_b16 v[44:45], v13 offset:8192
    ds_read_b64_tr_b16 v[46:47], v13 offset:8704
    ds_write_b128 v24, v[68:71] offset:1024
    s_waitcnt lgkmcnt(8)
    v_mfma_f32_32x32x16_bf16 v[96:111], a[12:15], v[56:59], v[96:111]
    ds_read_b64_tr_b16 v[48:49], v14 offset:8192
    ds_read_b64_tr_b16 v[50:51], v14 offset:8704
    ds_write_b128 v24, v[72:75] offset:2048
    s_waitcnt lgkmcnt(9)
    v_mfma_f32_32x32x16_bf16 v[112:127], a[12:15], v[60:63], v[112:127]
    ds_read_b64_tr_b16 v[52:53], v15 offset:8192
    ds_read_b64_tr_b16 v[54:55], v15 offset:8704
    ds_write_b128 v24, v[76:79] offset:3072
    s_waitcnt lgkmcnt(10)
    v_mfma_f32_32x32x16_bf16 v[96:111], a[16:19], v[40:43], v[96:111]
    ds_read_b64_tr_b16 v[56:57], v16 offset:8192
    ds_read_b64_tr_b16 v[58:59], v16 offset:8704
    ds_write_b128 v24, v[80:83] offset:16384
    s_waitcnt lgkmcnt(10)
    v_mfma_f32_32x32x16_bf16 v[112:127], a[16:19], v[44:47], v[112:127]
    ds_read_b64_tr_b16 v[60:61], v17 offset:8192
    ds_read_b64_tr_b16 v[62:63], v17 offset:8704
    ds_write_b128 v24, v[84:87] offset:17408
    s_waitcnt lgkmcnt(10)
    v_mfma_f32_32x32x16_bf16 v[96:111], a[20:23], v[48:51], v[96:111]
    ds_read_b64_tr_b16 v[40:41], v18 offset:8192
    ds_read_b64_tr_b16 v[42:43], v18 offset:8704
    ds_write_b128 v24, v[88:91] offset:18432
    s_waitcnt lgkmcnt(10)
    v_mfma_f32_32x32x16_bf16 v[112:127], a[20:23], v[52:55], v[112:127]
    ds_read_b64_tr_b16 v[44:45], v19 offset:8192
    ds_read_b64_tr_b16 v[46:47], v19 offset:8704
    ds_write_b128 v24, v[92:95] offset:19456
    s_waitcnt lgkmcnt(0)
    s_barrier
    buffer_load_dwordx2 v[72:73], v6, s[20:23], s26 offen offset:0
    buffer_load_dwordx2 v[74:75], v6, s[20:23], s26 offen offset:16
    buffer_load_dwordx2 v[76:77], v6, s[20:23], s26 offen offset:32
    buffer_load_dwordx2 v[78:79], v6, s[20:23], s26 offen offset:48
    buffer_load_dwordx4 v[80:83], v7, s[8:11], s27 offen offset:0
    buffer_load_dwordx4 v[84:87], v7, s[8:11], s27 offen offset:32
    buffer_load_dwordx4 v[88:91], v7, s[8:11], s27 offen offset:64
    buffer_load_dwordx4 v[92:95], v7, s[8:11], s27 offen offset:96
    v_mfma_f32_32x32x16_bf16 v[96:111], a[24:27], v[56:59], v[96:111]
    ds_read_b64_tr_b16 v[48:49], v12 offset:16384
    ds_read_b64_tr_b16 v[50:51], v12 offset:16896
    v_mfma_f32_32x32x16_bf16 v[112:127], a[24:27], v[60:63], v[112:127]
    ds_read_b64_tr_b16 v[52:53], v13 offset:16384
    ds_read_b64_tr_b16 v[54:55], v13 offset:16896
    v_mfma_f32_32x32x16_bf16 v[96:111], a[28:31], v[40:43], v[96:111]
    ds_read_b64_tr_b16 v[56:57], v14 offset:16384
    ds_read_b64_tr_b16 v[58:59], v14 offset:16896
    v_mfma_f32_32x32x16_bf16 v[112:127], a[28:31], v[44:47], v[112:127]
    ds_read_b64_tr_b16 v[60:61], v15 offset:16384
    ds_read_b64_tr_b16 v[62:63], v15 offset:16896
    s_waitcnt lgkmcnt(6)
    v_mfma_f32_32x32x16_bf16 v[96:111], a[32:35], v[48:51], v[96:111]
    ds_read_b64_tr_b16 v[40:41], v16 offset:16384
    ds_read_b64_tr_b16 v[42:43], v16 offset:16896
    s_waitcnt lgkmcnt(6)
    v_mfma_f32_32x32x16_bf16 v[112:127], a[32:35], v[52:55], v[112:127]
    ds_read_b64_tr_b16 v[44:45], v17 offset:16384
    ds_read_b64_tr_b16 v[46:47], v17 offset:16896
    s_waitcnt lgkmcnt(6)
    v_mfma_f32_32x32x16_bf16 v[96:111], a[36:39], v[56:59], v[96:111]
    ds_read_b64_tr_b16 v[48:49], v18 offset:16384
    ds_read_b64_tr_b16 v[50:51], v18 offset:16896
    s_waitcnt lgkmcnt(6)
    v_mfma_f32_32x32x16_bf16 v[112:127], a[36:39], v[60:63], v[112:127]
    ds_read_b64_tr_b16 v[52:53], v19 offset:16384
    ds_read_b64_tr_b16 v[54:55], v19 offset:16896
    s_waitcnt lgkmcnt(6)
    v_mfma_f32_32x32x16_bf16 v[96:111], a[40:43], v[40:43], v[96:111]
    ds_read_b64_tr_b16 v[56:57], v12 offset:24576
    ds_read_b64_tr_b16 v[58:59], v12 offset:25088
    s_waitcnt lgkmcnt(6)
    v_mfma_f32_32x32x16_bf16 v[112:127], a[40:43], v[44:47], v[112:127]
    ds_read_b64_tr_b16 v[60:61], v13 offset:24576
    ds_read_b64_tr_b16 v[62:63], v13 offset:25088
    s_waitcnt lgkmcnt(6)
    v_mfma_f32_32x32x16_bf16 v[96:111], a[44:47], v[48:51], v[96:111]
    ds_read_b64_tr_b16 v[40:41], v14 offset:24576
    ds_read_b64_tr_b16 v[42:43], v14 offset:25088
    s_waitcnt lgkmcnt(6)
    v_mfma_f32_32x32x16_bf16 v[112:127], a[44:47], v[52:55], v[112:127]
    ds_read_b64_tr_b16 v[44:45], v15 offset:24576
    ds_read_b64_tr_b16 v[46:47], v15 offset:25088
    s_waitcnt lgkmcnt(6)
    v_mfma_f32_32x32x16_bf16 v[96:111], a[48:51], v[56:59], v[96:111]
    ds_read_b64_tr_b16 v[48:49], v16 offset:24576
    ds_read_b64_tr_b16 v[50:51], v16 offset:25088
    s_waitcnt lgkmcnt(6)
    v_mfma_f32_32x32x16_bf16 v[112:127], a[48:51], v[60:63], v[112:127]
    ds_read_b64_tr_b16 v[52:53], v17 offset:24576
    ds_read_b64_tr_b16 v[54:55], v17 offset:25088
    s_waitcnt lgkmcnt(6)
    v_mfma_f32_32x32x16_bf16 v[96:111], a[52:55], v[40:43], v[96:111]
    ds_read_b64_tr_b16 v[56:57], v18 offset:24576
    ds_read_b64_tr_b16 v[58:59], v18 offset:25088
    s_waitcnt lgkmcnt(6)
    v_mfma_f32_32x32x16_bf16 v[112:127], a[52:55], v[44:47], v[112:127]
    ds_read_b64_tr_b16 v[60:61], v19 offset:24576
    ds_read_b64_tr_b16 v[62:63], v19 offset:25088
    s_waitcnt lgkmcnt(6)
    v_mfma_f32_32x32x16_bf16 v[96:111], a[56:59], v[48:51], v[96:111]
    ds_read_b64_tr_b16 v[40:41], v12 offset:32768
    ds_read_b64_tr_b16 v[42:43], v12 offset:33280
    s_waitcnt lgkmcnt(6)
    v_mfma_f32_32x32x16_bf16 v[112:127], a[56:59], v[52:55], v[112:127]
    ds_read_b64_tr_b16 v[44:45], v13 offset:32768
    ds_read_b64_tr_b16 v[46:47], v13 offset:33280
    s_waitcnt lgkmcnt(6)
    v_mfma_f32_32x32x16_bf16 v[96:111], a[60:63], v[56:59], v[96:111]
    ds_read_b64_tr_b16 v[48:49], v14 offset:32768
    ds_read_b64_tr_b16 v[50:51], v14 offset:33280
    s_waitcnt lgkmcnt(6)
    v_mfma_f32_32x32x16_bf16 v[112:127], a[60:63], v[60:63], v[112:127]
    ds_read_b64_tr_b16 v[52:53], v15 offset:32768
    ds_read_b64_tr_b16 v[54:55], v15 offset:33280
    s_waitcnt lgkmcnt(6)
    v_mfma_f32_32x32x16_bf16 v[96:111], a[64:67], v[40:43], v[96:111]
    ds_read_b64_tr_b16 v[56:57], v16 offset:32768
    ds_read_b64_tr_b16 v[58:59], v16 offset:33280
    s_waitcnt lgkmcnt(6)
    v_mfma_f32_32x32x16_bf16 v[112:127], a[64:67], v[44:47], v[112:127]
    ds_read_b64_tr_b16 v[60:61], v17 offset:32768
    ds_read_b64_tr_b16 v[62:63], v17 offset:33280
    s_waitcnt lgkmcnt(6)
    v_mfma_f32_32x32x16_bf16 v[96:111], a[68:71], v[48:51], v[96:111]
    ds_read_b64_tr_b16 v[40:41], v18 offset:32768
    ds_read_b64_tr_b16 v[42:43], v18 offset:33280
    buffer_load_dwordx2 v[8:9], v25, s[8:11], s46 offen offset:512 sc1
    buffer_load_dwordx2 v[10:11], v25, s[8:11], s46 offen offset:768 sc1
    s_waitcnt lgkmcnt(6)
    v_mfma_f32_32x32x16_bf16 v[112:127], a[68:71], v[52:55], v[112:127]
    ds_read_b64_tr_b16 v[44:45], v19 offset:32768
    ds_read_b64_tr_b16 v[46:47], v19 offset:33280
    s_waitcnt lgkmcnt(6)
    v_mfma_f32_32x32x16_bf16 v[96:111], a[72:75], v[56:59], v[96:111]
    ds_read_b64_tr_b16 v[48:49], v12 offset:40960
    ds_read_b64_tr_b16 v[50:51], v12 offset:41472
    s_waitcnt lgkmcnt(6)
    v_mfma_f32_32x32x16_bf16 v[112:127], a[72:75], v[60:63], v[112:127]
    ds_read_b64_tr_b16 v[52:53], v13 offset:40960
    ds_read_b64_tr_b16 v[54:55], v13 offset:41472
    s_mov_b32 s84, s79
    s_add_u32 s85, s80, s84
    s_add_u32 s86, s81, s84
    buffer_load_dwordx4 a[0:3], v31, s[8:11], s85 offen
    buffer_load_dwordx4 a[4:7], v31, s[8:11], s86 offen
    s_add_u32 s84, s84, 1024
    s_cmp_eq_u32 s84, 14336
    s_cselect_b32 s84, 0, s84
    s_waitcnt lgkmcnt(6)
    v_mfma_f32_32x32x16_bf16 v[96:111], a[76:79], v[40:43], v[96:111]
    ds_read_b64_tr_b16 v[56:57], v14 offset:40960
    ds_read_b64_tr_b16 v[58:59], v14 offset:41472
    s_waitcnt lgkmcnt(6)
    v_mfma_f32_32x32x16_bf16 v[112:127], a[76:79], v[44:47], v[112:127]
    ds_read_b64_tr_b16 v[60:61], v15 offset:40960
    ds_read_b64_tr_b16 v[62:63], v15 offset:41472
    s_add_u32 s85, s80, s84
    s_add_u32 s86, s81, s84
    buffer_load_dwordx4 a[8:11], v31, s[8:11], s85 offen
    buffer_load_dwordx4 a[12:15], v31, s[8:11], s86 offen
    s_add_u32 s84, s84, 1024
    s_cmp_eq_u32 s84, 14336
    s_cselect_b32 s84, 0, s84
    s_waitcnt lgkmcnt(6)
    v_mfma_f32_32x32x16_bf16 v[96:111], a[80:83], v[48:51], v[96:111]
    ds_read_b64_tr_b16 v[40:41], v16 offset:40960
    ds_read_b64_tr_b16 v[42:43], v16 offset:41472
    s_waitcnt lgkmcnt(6)
    v_mfma_f32_32x32x16_bf16 v[112:127], a[80:83], v[52:55], v[112:127]
    ds_read_b64_tr_b16 v[44:45], v17 offset:40960
    ds_read_b64_tr_b16 v[46:47], v17 offset:41472
    s_add_u32 s85, s80, s84
    s_add_u32 s86, s81, s84
    buffer_load_dwordx4 a[16:19], v31, s[8:11], s85 offen
    buffer_load_dwordx4 a[20:23], v31, s[8:11], s86 offen
    s_add_u32 s84, s84, 1024
    s_cmp_eq_u32 s84, 14336
    s_cselect_b32 s84, 0, s84
    s_waitcnt lgkmcnt(6)
    v_mfma_f32_32x32x16_bf16 v[96:111], a[84:87], v[56:59], v[96:111]
    ds_read_b64_tr_b16 v[48:49], v18 offset:40960
    ds_read_b64_tr_b16 v[50:51], v18 offset:41472
    s_waitcnt lgkmcnt(6)
    v_mfma_f32_32x32x16_bf16 v[112:127], a[84:87], v[60:63], v[112:127]
    ds_read_b64_tr_b16 v[52:53], v19 offset:40960
    ds_read_b64_tr_b16 v[54:55], v19 offset:41472
    s_add_u32 s85, s80, s84
    s_add_u32 s86, s81, s84
    buffer_load_dwordx4 a[24:27], v31, s[8:11], s85 offen
    buffer_load_dwordx4 a[28:31], v31, s[8:11], s86 offen
    s_add_u32 s84, s84, 1024
    s_cmp_eq_u32 s84, 14336
    s_cselect_b32 s84, 0, s84
    s_waitcnt lgkmcnt(6)
    v_mfma_f32_32x32x16_bf16 v[96:111], a[88:91], v[40:43], v[96:111]
    ds_read_b64_tr_b16 v[56:57], v12 offset:49152
    ds_read_b64_tr_b16 v[58:59], v12 offset:49664
    s_waitcnt lgkmcnt(6)
    v_mfma_f32_32x32x16_bf16 v[112:127], a[88:91], v[44:47], v[112:127]
    ds_read_b64_tr_b16 v[60:61], v13 offset:49152
    ds_read_b64_tr_b16 v[62:63], v13 offset:49664
    s_add_u32 s85, s80, s84
    s_add_u32 s86, s81, s84
    buffer_load_dwordx4 a[32:35], v31, s[8:11], s85 offen
    buffer_load_dwordx4 a[36:39], v31, s[8:11], s86 offen
    s_add_u32 s84, s84, 1024
    s_cmp_eq_u32 s84, 14336
    s_cselect_b32 s84, 0, s84
    s_waitcnt lgkmcnt(6)
    v_mfma_f32_32x32x16_bf16 v[96:111], a[92:95], v[48:51], v[96:111]
    ds_read_b64_tr_b16 v[40:41], v14 offset:49152
    ds_read_b64_tr_b16 v[42:43], v14 offset:49664
    s_waitcnt lgkmcnt(6)
    v_mfma_f32_32x32x16_bf16 v[112:127], a[92:95], v[52:55], v[112:127]
    ds_read_b64_tr_b16 v[44:45], v15 offset:49152
    ds_read_b64_tr_b16 v[46:47], v15 offset:49664
    s_add_u32 s85, s80, s84
    s_add_u32 s86, s81, s84
    buffer_load_dwordx4 a[40:43], v31, s[8:11], s85 offen
    buffer_load_dwordx4 a[44:47], v31, s[8:11], s86 offen
    s_add_u32 s84, s84, 1024
    s_cmp_eq_u32 s84, 14336
    s_cselect_b32 s84, 0, s84
    s_waitcnt lgkmcnt(6)
    v_mfma_f32_32x32x16_bf16 v[96:111], a[96:99], v[56:59], v[96:111]
    ds_read_b64_tr_b16 v[48:49], v16 offset:49152
    ds_read_b64_tr_b16 v[50:51], v16 offset:49664
    s_waitcnt lgkmcnt(6)
    v_mfma_f32_32x32x16_bf16 v[112:127], a[96:99], v[60:63], v[112:127]
    ds_read_b64_tr_b16 v[52:53], v17 offset:49152
    ds_read_b64_tr_b16 v[54:55], v17 offset:49664
    s_add_u32 s85, s80, s84
    s_add_u32 s86, s81, s84
    buffer_load_dwordx4 a[48:51], v31, s[8:11], s85 offen
    buffer_load_dwordx4 a[52:55], v31, s[8:11], s86 offen
    s_add_u32 s84, s84, 1024
    s_cmp_eq_u32 s84, 14336
    s_cselect_b32 s84, 0, s84
    s_waitcnt lgkmcnt(6)
    v_mfma_f32_32x32x16_bf16 v[96:111], a[100:103], v[40:43], v[96:111]
    ds_read_b64_tr_b16 v[56:57], v18 offset:49152
    ds_read_b64_tr_b16 v[58:59], v18 offset:49664
    s_waitcnt lgkmcnt(6)
    v_mfma_f32_32x32x16_bf16 v[112:127], a[100:103], v[44:47], v[112:127]
    ds_read_b64_tr_b16 v[60:61], v19 offset:49152
    ds_read_b64_tr_b16 v[62:63], v19 offset:49664
    s_add_u32 s85, s80, s84
    s_add_u32 s86, s81, s84
    buffer_load_dwordx4 a[56:59], v31, s[8:11], s85 offen
    buffer_load_dwordx4 a[60:63], v31, s[8:11], s86 offen
    s_add_u32 s84, s84, 1024
    s_cmp_eq_u32 s84, 14336
    s_cselect_b32 s84, 0, s84
    s_waitcnt lgkmcnt(6)
    v_mfma_f32_32x32x16_bf16 v[96:111], a[104:107], v[48:51], v[96:111]
    ds_read_b64_tr_b16 v[40:41], v12 offset:57344
    ds_read_b64_tr_b16 v[42:43], v12 offset:57856
    s_waitcnt lgkmcnt(6)
    v_mfma_f32_32x32x16_bf16 v[112:127], a[104:107], v[52:55], v[112:127]
    ds_read_b64_tr_b16 v[44:45], v13 offset:57344
    ds_read_b64_tr_b16 v[46:47], v13 offset:57856
    s_add_u32 s85, s80, s84
    s_add_u32 s86, s81, s84
    buffer_load_dwordx4 a[64:67], v31, s[8:11], s85 offen
    buffer_load_dwordx4 a[68:71], v31, s[8:11], s86 offen
    s_add_u32 s84, s84, 1024
    s_cmp_eq_u32 s84, 14336
    s_cselect_b32 s84, 0, s84
    s_waitcnt lgkmcnt(6)
    v_mfma_f32_32x32x16_bf16 v[96:111], a[108:111], v[56:59], v[96:111]
    ds_read_b64_tr_b16 v[48:49], v14 offset:57344
    ds_read_b64_tr_b16 v[50:51], v14 offset:57856
    s_waitcnt lgkmcnt(6)
    v_mfma_f32_32x32x16_bf16 v[112:127], a[108:111], v[60:63], v[112:127]
    ds_read_b64_tr_b16 v[52:53], v15 offset:57344
    ds_read_b64_tr_b16 v[54:55], v15 offset:57856
    s_add_u32 s85, s80, s84
    s_add_u32 s86, s81, s84
    buffer_load_dwordx4 a[72:75], v31, s[8:11], s85 offen
    buffer_load_dwordx4 a[76:79], v31, s[8:11], s86 offen
    s_add_u32 s84, s84, 1024
    s_cmp_eq_u32 s84, 14336
    s_cselect_b32 s84, 0, s84
    s_waitcnt lgkmcnt(6)
    v_mfma_f32_32x32x16_bf16 v[96:111], a[112:115], v[40:43], v[96:111]
    ds_read_b64_tr_b16 v[56:57], v16 offset:57344
    ds_read_b64_tr_b16 v[58:59], v16 offset:57856
    s_waitcnt lgkmcnt(6)
    v_mfma_f32_32x32x16_bf16 v[112:127], a[112:115], v[44:47], v[112:127]
    ds_read_b64_tr_b16 v[60:61], v17 offset:57344
    ds_read_b64_tr_b16 v[62:63], v17 offset:57856
    s_add_u32 s85, s80, s84
    s_add_u32 s86, s81, s84
    buffer_load_dwordx4 a[80:83], v31, s[8:11], s85 offen
    buffer_load_dwordx4 a[84:87], v31, s[8:11], s86 offen
    s_add_u32 s84, s84, 1024
    s_cmp_eq_u32 s84, 14336
    s_cselect_b32 s84, 0, s84
    s_waitcnt lgkmcnt(6)
    v_mfma_f32_32x32x16_bf16 v[96:111], a[116:119], v[48:51], v[96:111]
    ds_read_b64_tr_b16 v[40:41], v18 offset:57344
    ds_read_b64_tr_b16 v[42:43], v18 offset:57856
    s_waitcnt lgkmcnt(6)
    v_mfma_f32_32x32x16_bf16 v[112:127], a[116:119], v[52:55], v[112:127]
    ds_read_b64_tr_b16 v[44:45], v19 offset:57344
    ds_read_b64_tr_b16 v[46:47], v19 offset:57856
    s_add_u32 s85, s80, s84
    s_add_u32 s86, s81, s84
    buffer_load_dwordx4 a[88:91], v31, s[8:11], s85 offen
    buffer_load_dwordx4 a[92:95], v31, s[8:11], s86 offen
    s_add_u32 s84, s84, 1024
    s_cmp_eq_u32 s84, 14336
    s_cselect_b32 s84, 0, s84
    s_waitcnt lgkmcnt(6)
    v_mfma_f32_32x32x16_bf16 v[96:111], a[120:123], v[56:59], v[96:111]
    s_waitcnt lgkmcnt(4)
    v_mfma_f32_32x32x16_bf16 v[112:127], a[120:123], v[60:63], v[112:127]
    s_add_u32 s85, s80, s84
    s_add_u32 s86, s81, s84
    buffer_load_dwordx4 a[96:99], v31, s[8:11], s85 offen
    buffer_load_dwordx4 a[100:103], v31, s[8:11], s86 offen
    s_add_u32 s84, s84, 1024
    s_cmp_eq_u32 s84, 14336
    s_cselect_b32 s84, 0, s84
    s_waitcnt lgkmcnt(2)
    v_mfma_f32_32x32x16_bf16 v[96:111], a[124:127], v[40:43], v[96:111]
    s_waitcnt lgkmcnt(0)
    v_mfma_f32_32x32x16_bf16 v[112:127], a[124:127], v[44:47], v[112:127]
    s_add_u32 s85, s80, s84
    s_add_u32 s86, s81, s84
    buffer_load_dwordx4 a[104:107], v31, s[8:11], s85 offen
    buffer_load_dwordx4 a[108:111], v31, s[8:11], s86 offen
    s_add_u32 s84, s84, 1024
    s_cmp_eq_u32 s84, 14336
    s_cselect_b32 s84, 0, s84
    s_waitcnt vmcnt(28)
    v_lshlrev_b32 v40, 16, v72
    v_and_b32 v41, 0xffff0000, v72
    v_lshlrev_b32 v42, 16, v73
    v_and_b32 v43, 0xffff0000, v73
    v_lshlrev_b32 v44, 16, v74
    v_and_b32 v45, 0xffff0000, v74
    v_lshlrev_b32 v46, 16, v75
    v_and_b32 v47, 0xffff0000, v75
    v_lshlrev_b32 v48, 16, v76
    v_and_b32 v49, 0xffff0000, v76
    v_lshlrev_b32 v50, 16, v77
    v_and_b32 v51, 0xffff0000, v77
    v_lshlrev_b32 v52, 16, v78
    v_and_b32 v53, 0xffff0000, v78
    v_lshlrev_b32 v54, 16, v79
    v_and_b32 v55, 0xffff0000, v79
    v_mov_b32 v28, 1
    s_waitcnt lgkmcnt(0)
    ds_write_b32 v29, v28
    s_mov_b32 s44, 0
Lg1_msp:
    v_min_u32 v20, v8, v10
    v_cmp_eq_u32 vcc, 0, v20
    s_cmp_eq_u64 vcc, 0
    s_cbranch_scc1 Lg1_mok
    s_sleep 4
    buffer_load_dwordx2 v[8:9], v25, s[8:11], s46 offen offset:512 sc1
    buffer_load_dwordx2 v[10:11], v25, s[8:11], s46 offen offset:768 sc1
    s_add_u32 s44, s44, 1
    s_waitcnt vmcnt(0)
    s_cmp_lt_u32 s44, 40000
    s_cbranch_scc1 Lg1_msp
Lg1_mok:
    v_mov_b32 v12, v8
    v_mov_b32 v13, v9
    v_mov_b32 v14, v10
    v_mov_b32 v15, v11
    v_pk_fma_f32 v[60:61], v[14:15], v[80:81], v[40:41] op_sel:[1,0,0] op_sel_hi:[1,1,1] neg_lo:[1,0,0] neg_hi:[1,0,0]
    v_pk_fma_f32 v[62:63], v[14:15], v[82:83], v[42:43] op_sel:[1,0,0] op_sel_hi:[1,1,1] neg_lo:[1,0,0] neg_hi:[1,0,0]
    v_pk_fma_f32 v[112:113], v[112:113], v[14:15], v[60:61] op_sel:[0,0,0] op_sel_hi:[1,0,1]
    v_pk_fma_f32 v[114:115], v[114:115], v[14:15], v[62:63] op_sel:[0,0,0] op_sel_hi:[1,0,1]
    v_pk_mul_f32 v[56:57], v[112:113], v[112:113]
    v_pk_mul_f32 v[58:59], v[114:115], v[114:115]
    v_pk_fma_f32 v[56:57], v[56:57], s[30:31], v[26:27]
    v_pk_fma_f32 v[58:59], v[58:59], s[30:31], v[26:27]
    v_pk_mul_f32 v[56:57], v[56:57], v[112:113]
    v_pk_mul_f32 v[58:59], v[58:59], v[114:115]
    v_exp_f32 v56, v56
    v_exp_f32 v57, v57
    v_exp_f32 v58, v58
    v_exp_f32 v59, v59
    s_nop 0
    v_pk_add_f32 v[56:57], v[56:57], 1.0 op_sel_hi:[1,0]
    v_pk_add_f32 v[58:59], v[58:59], 1.0 op_sel_hi:[1,0]
    v_rcp_f32 v56, v56
    v_rcp_f32 v57, v57
    v_rcp_f32 v58, v58
    v_rcp_f32 v59, v59
    s_nop 0
    v_pk_mul_f32 v[112:113], v[112:113], v[56:57]
    v_pk_mul_f32 v[114:115], v[114:115], v[58:59]
    v_cvt_pk_bf16_f32 v32, v112, v113
    v_cvt_pk_bf16_f32 v33, v114, v115
    v_pk_fma_f32 v[60:61], v[14:15], v[84:85], v[44:45] op_sel:[1,0,0] op_sel_hi:[1,1,1] neg_lo:[1,0,0] neg_hi:[1,0,0]
    v_pk_fma_f32 v[62:63], v[14:15], v[86:87], v[46:47] op_sel:[1,0,0] op_sel_hi:[1,1,1] neg_lo:[1,0,0] neg_hi:[1,0,0]
    v_pk_fma_f32 v[116:117], v[116:117], v[14:15], v[60:61] op_sel:[0,0,0] op_sel_hi:[1,0,1]
    v_pk_fma_f32 v[118:119], v[118:119], v[14:15], v[62:63] op_sel:[0,0,0] op_sel_hi:[1,0,1]
    v_pk_mul_f32 v[56:57], v[116:117], v[116:117]
    v_pk_mul_f32 v[58:59], v[118:119], v[118:119]
    v_pk_fma_f32 v[56:57], v[56:57], s[30:31], v[26:27]
    v_pk_fma_f32 v[58:59], v[58:59], s[30:31], v[26:27]
    v_pk_mul_f32 v[56:57], v[56:57], v[116:117]
    v_pk_mul_f32 v[58:59], v[58:59], v[118:119]
    v_exp_f32 v56, v56
    v_exp_f32 v57, v57
    v_exp_f32 v58, v58
    v_exp_f32 v59, v59
    s_nop 0
    v_pk_add_f32 v[56:57], v[56:57], 1.0 op_sel_hi:[1,0]
    v_pk_add_f32 v[58:59], v[58:59], 1.0 op_sel_hi:[1,0]
    v_rcp_f32 v56, v56
    v_rcp_f32 v57, v57
    v_rcp_f32 v58, v58
    v_rcp_f32 v59, v59
    s_nop 0
    v_pk_mul_f32 v[116:117], v[116:117], v[56:57]
    v_pk_mul_f32 v[118:119], v[118:119], v[58:59]
    v_cvt_pk_bf16_f32 v34, v116, v117
    v_cvt_pk_bf16_f32 v35, v118, v119
    v_pk_fma_f32 v[60:61], v[14:15], v[88:89], v[48:49] op_sel:[1,0,0] op_sel_hi:[1,1,1] neg_lo:[1,0,0] neg_hi:[1,0,0]
    v_pk_fma_f32 v[62:63], v[14:15], v[90:91], v[50:51] op_sel:[1,0,0] op_sel_hi:[1,1,1] neg_lo:[1,0,0] neg_hi:[1,0,0]
    v_pk_fma_f32 v[120:121], v[120:121], v[14:15], v[60:61] op_sel:[0,0,0] op_sel_hi:[1,0,1]
    v_pk_fma_f32 v[122:123], v[122:123], v[14:15], v[62:63] op_sel:[0,0,0] op_sel_hi:[1,0,1]
    v_pk_mul_f32 v[56:57], v[120:121], v[120:121]
    v_pk_mul_f32 v[58:59], v[122:123], v[122:123]
    v_pk_fma_f32 v[56:57], v[56:57], s[30:31], v[26:27]
    v_pk_fma_f32 v[58:59], v[58:59], s[30:31], v[26:27]
    v_pk_mul_f32 v[56:57], v[56:57], v[120:121]
    v_pk_mul_f32 v[58:59], v[58:59], v[122:123]
    v_exp_f32 v56, v56
    v_exp_f32 v57, v57
    v_exp_f32 v58, v58
    v_exp_f32 v59, v59
    s_nop 0
    v_pk_add_f32 v[56:57], v[56:57], 1.0 op_sel_hi:[1,0]
    v_pk_add_f32 v[58:59], v[58:59], 1.0 op_sel_hi:[1,0]
    v_rcp_f32 v56, v56
    v_rcp_f32 v57, v57
    v_rcp_f32 v58, v58
    v_rcp_f32 v59, v59
    s_nop 0
    v_pk_mul_f32 v[120:121], v[120:121], v[56:57]
    v_pk_mul_f32 v[122:123], v[122:123], v[58:59]
    v_cvt_pk_bf16_f32 v36, v120, v121
    v_cvt_pk_bf16_f32 v37, v122, v123
    v_pk_fma_f32 v[60:61], v[14:15], v[92:93], v[52:53] op_sel:[1,0,0] op_sel_hi:[1,1,1] neg_lo:[1,0,0] neg_hi:[1,0,0]
    v_pk_fma_f32 v[62:63], v[14:15], v[94:95], v[54:55] op_sel:[1,0,0] op_sel_hi:[1,1,1] neg_lo:[1,0,0] neg_hi:[1,0,0]
    v_pk_fma_f32 v[124:125], v[124:125], v[14:15], v[60:61] op_sel:[0,0,0] op_sel_hi:[1,0,1]
    v_pk_fma_f32 v[126:127], v[126:127], v[14:15], v[62:63] op_sel:[0,0,0] op_sel_hi:[1,0,1]
    v_pk_mul_f32 v[56:57], v[124:125], v[124:125]
    v_pk_mul_f32 v[58:59], v[126:127], v[126:127]
    v_pk_fma_f32 v[56:57], v[56:57], s[30:31], v[26:27]
    v_pk_fma_f32 v[58:59], v[58:59], s[30:31], v[26:27]
    v_pk_mul_f32 v[56:57], v[56:57], v[124:125]
    v_pk_mul_f32 v[58:59], v[58:59], v[126:127]
    v_exp_f32 v56, v56
    v_exp_f32 v57, v57
    v_exp_f32 v58, v58
    v_exp_f32 v59, v59
    s_nop 0
    v_pk_add_f32 v[56:57], v[56:57], 1.0 op_sel_hi:[1,0]
    v_pk_add_f32 v[58:59], v[58:59], 1.0 op_sel_hi:[1,0]
    v_rcp_f32 v56, v56
    v_rcp_f32 v57, v57
    v_rcp_f32 v58, v58
    v_rcp_f32 v59, v59
    s_nop 0
    v_pk_mul_f32 v[124:125], v[124:125], v[56:57]
    v_pk_mul_f32 v[126:127], v[126:127], v[58:59]
    v_cvt_pk_bf16_f32 v38, v124, v125
    v_cvt_pk_bf16_f32 v39, v126, v127
    s_add_u32 s35, s34, 344064
    buffer_store_dwordx4 v[32:35], v3, s[8:11], s35 offen sc1
    buffer_store_dwordx4 v[36:39], v3, s[8:11], s35 offen offset:1024 sc1
    v_pk_fma_f32 v[60:61], v[12:13], v[88:89], v[48:49] op_sel:[1,0,0] op_sel_hi:[1,1,1] neg_lo:[1,0,0] neg_hi:[1,0,0]
    v_pk_fma_f32 v[62:63], v[12:13], v[90:91], v[50:51] op_sel:[1,0,0] op_sel_hi:[1,1,1] neg_lo:[1,0,0] neg_hi:[1,0,0]
    v_pk_fma_f32 v[104:105], v[104:105], v[12:13], v[60:61] op_sel:[0,0,0] op_sel_hi:[1,0,1]
    v_pk_fma_f32 v[106:107], v[106:107], v[12:13], v[62:63] op_sel:[0,0,0] op_sel_hi:[1,0,1]
    v_pk_mul_f32 v[56:57], v[104:105], v[104:105]
    v_pk_mul_f32 v[58:59], v[106:107], v[106:107]
    v_pk_fma_f32 v[56:57], v[56:57], s[30:31], v[26:27]
    v_pk_fma_f32 v[58:59], v[58:59], s[30:31], v[26:27]
    v_pk_mul_f32 v[56:57], v[56:57], v[104:105]
    v_pk_mul_f32 v[58:59], v[58:59], v[106:107]
    v_exp_f32 v56, v56
    v_exp_f32 v57, v57
    v_exp_f32 v58, v58
    v_exp_f32 v59, v59
    s_nop 0
    v_pk_add_f32 v[56:57], v[56:57], 1.0 op_sel_hi:[1,0]
    v_pk_add_f32 v[58:59], v[58:59], 1.0 op_sel_hi:[1,0]
    v_rcp_f32 v56, v56
    v_rcp_f32 v57, v57
    v_rcp_f32 v58, v58
    v_rcp_f32 v59, v59
    s_nop 0
    v_pk_mul_f32 v[104:105], v[104:105], v[56:57]
    v_pk_mul_f32 v[106:107], v[106:107], v[58:59]
    v_cvt_pk_bf16_f32 v16, v104, v105
    v_cvt_pk_bf16_f32 v17, v106, v107
    v_pk_fma_f32 v[60:61], v[12:13], v[92:93], v[52:53] op_sel:[1,0,0] op_sel_hi:[1,1,1] neg_lo:[1,0,0] neg_hi:[1,0,0]
    v_pk_fma_f32 v[62:63], v[12:13], v[94:95], v[54:55] op_sel:[1,0,0] op_sel_hi:[1,1,1] neg_lo:[1,0,0] neg_hi:[1,0,0]
    v_pk_fma_f32 v[108:109], v[108:109], v[12:13], v[60:61] op_sel:[0,0,0] op_sel_hi:[1,0,1]
    v_pk_fma_f32 v[110:111], v[110:111], v[12:13], v[62:63] op_sel:[0,0,0] op_sel_hi:[1,0,1]
    v_pk_mul_f32 v[56:57], v[108:109], v[108:109]
    v_pk_mul_f32 v[58:59], v[110:111], v[110:111]
    v_pk_fma_f32 v[56:57], v[56:57], s[30:31], v[26:27]
    v_pk_fma_f32 v[58:59], v[58:59], s[30:31], v[26:27]
    v_pk_mul_f32 v[56:57], v[56:57], v[108:109]
    v_pk_mul_f32 v[58:59], v[58:59], v[110:111]
    v_exp_f32 v56, v56
    v_exp_f32 v57, v57
    v_exp_f32 v58, v58
    v_exp_f32 v59, v59
    s_nop 0
    v_pk_add_f32 v[56:57], v[56:57], 1.0 op_sel_hi:[1,0]
    v_pk_add_f32 v[58:59], v[58:59], 1.0 op_sel_hi:[1,0]
    v_rcp_f32 v56, v56
    v_rcp_f32 v57, v57
    v_rcp_f32 v58, v58
    v_rcp_f32 v59, v59
    s_nop 0
    v_pk_mul_f32 v[108:109], v[108:109], v[56:57]
    v_pk_mul_f32 v[110:111], v[110:111], v[58:59]
    v_cvt_pk_bf16_f32 v18, v108, v109
    v_cvt_pk_bf16_f32 v19, v110, v111
    s_add_u32 s35, s34, 229376
    buffer_store_dwordx4 v[16:19], v3, s[8:11], s35 offen offset:1024 sc1
    v_pk_fma_f32 v[60:61], v[12:13], v[80:81], v[40:41] op_sel:[1,0,0] op_sel_hi:[1,1,1] neg_lo:[1,0,0] neg_hi:[1,0,0]
    v_pk_fma_f32 v[62:63], v[12:13], v[82:83], v[42:43] op_sel:[1,0,0] op_sel_hi:[1,1,1] neg_lo:[1,0,0] neg_hi:[1,0,0]
    v_pk_fma_f32 v[96:97], v[96:97], v[12:13], v[60:61] op_sel:[0,0,0] op_sel_hi:[1,0,1]
    v_pk_fma_f32 v[98:99], v[98:99], v[12:13], v[62:63] op_sel:[0,0,0] op_sel_hi:[1,0,1]
    v_pk_mul_f32 v[56:57], v[96:97], v[96:97]
    v_pk_mul_f32 v[58:59], v[98:99], v[98:99]
    v_pk_fma_f32 v[56:57], v[56:57], s[30:31], v[26:27]
    v_pk_fma_f32 v[58:59], v[58:59], s[30:31], v[26:27]
    v_pk_mul_f32 v[56:57], v[56:57], v[96:97]
    v_pk_mul_f32 v[58:59], v[58:59], v[98:99]
    v_exp_f32 v56, v56
    v_exp_f32 v57, v57
    v_exp_f32 v58, v58
    v_exp_f32 v59, v59
    s_nop 0
    v_pk_add_f32 v[56:57], v[56:57], 1.0 op_sel_hi:[1,0]
    v_pk_add_f32 v[58:59], v[58:59], 1.0 op_sel_hi:[1,0]
    v_rcp_f32 v56, v56
    v_rcp_f32 v57, v57
    v_rcp_f32 v58, v58
    v_rcp_f32 v59, v59
    s_nop 0
    v_pk_mul_f32 v[96:97], v[96:97], v[56:57]
    v_pk_mul_f32 v[98:99], v[98:99], v[58:59]
    v_cvt_pk_bf16_f32 v20, v96, v97
    v_cvt_pk_bf16_f32 v21, v98, v99
    v_pk_fma_f32 v[60:61], v[12:13], v[84:85], v[44:45] op_sel:[1,0,0] op_sel_hi:[1,1,1] neg_lo:[1,0,0] neg_hi:[1,0,0]
    v_pk_fma_f32 v[62:63], v[12:13], v[86:87], v[46:47] op_sel:[1,0,0] op_sel_hi:[1,1,1] neg_lo:[1,0,0] neg_hi:[1,0,0]
    v_pk_fma_f32 v[100:101], v[100:101], v[12:13], v[60:61] op_sel:[0,0,0] op_sel_hi:[1,0,1]
    v_pk_fma_f32 v[102:103], v[102:103], v[12:13], v[62:63] op_sel:[0,0,0] op_sel_hi:[1,0,1]
    v_pk_mul_f32 v[56:57], v[100:101], v[100:101]
    v_pk_mul_f32 v[58:59], v[102:103], v[102:103]
    v_pk_fma_f32 v[56:57], v[56:57], s[30:31], v[26:27]
    v_pk_fma_f32 v[58:59], v[58:59], s[30:31], v[26:27]
    v_pk_mul_f32 v[56:57], v[56:57], v[100:101]
    v_pk_mul_f32 v[58:59], v[58:59], v[102:103]
    v_exp_f32 v56, v56
    v_exp_f32 v57, v57
    v_exp_f32 v58, v58
    v_exp_f32 v59, v59
    s_nop 0
    v_pk_add_f32 v[56:57], v[56:57], 1.0 op_sel_hi:[1,0]
    v_pk_add_f32 v[58:59], v[58:59], 1.0 op_sel_hi:[1,0]
    v_rcp_f32 v56, v56
    v_rcp_f32 v57, v57
    v_rcp_f32 v58, v58
    v_rcp_f32 v59, v59
    s_nop 0
    v_pk_mul_f32 v[100:101], v[100:101], v[56:57]
    v_pk_mul_f32 v[102:103], v[102:103], v[58:59]
    v_cvt_pk_bf16_f32 v22, v100, v101
    v_cvt_pk_bf16_f32 v23, v102, v103
    buffer_store_dwordx4 v[20:23], v3, s[8:11], s35 offen sc1
    s_branch Lg1_fin
Lcm_conv:
    v_subrev_u32 v124, 256, v0
    s_and_b32 s3, s36, 3
    v_lshlrev_b32 v3, 4, v124
    v_lshlrev_b32 v4, 6, v124
    s_mul_i32 s12, s2, 8448
    s_add_u32 s13, s12, s60
    s_add_u32 s14, s13, 4224
    s_lshl_b32 s15, s2, 2
    s_waitcnt lgkmcnt(0)
    s_load_dword s16, s[64:65], s15
    s_mov_b32 s8, s4
    s_mov_b32 s9, s5
    s_mov_b32 s10, 0x10000000
    s_mov_b32 s11, 0x00020000
    buffer_load_dwordx4 v[16:19], v4, s[8:11], s61 offen
    buffer_load_dwordx4 v[20:23], v4, s[8:11], s61 offen offset:16
    buffer_load_dwordx4 v[24:27], v4, s[8:11], s61 offen offset:32
    buffer_load_dwordx4 v[28:31], v4, s[8:11], s61 offen offset:48
    buffer_load_dwordx4 v[8:11], v3, s[8:11], s13 offen
    buffer_load_dwordx4 v[12:15], v3, s[8:11], s14 offen
    s_lshr_b32 s17, s3, 1
    s_and_b32 s18, s3, 1
    s_lshl_b32 s19, s2, 1
    s_add_u32 s19, s19, s17
    s_mul_i32 s20, s19, 4352
    s_add_u32 s20, s20, 29360248
    s_lshl_b32 s21, s18, 2
    s_sub_u32 s20, s20, s21
    s_mul_i32 s22, s3, 8832
    s_add_u32 s22, s22, 112
    v_lshlrev_b32 v5, 4, v1
    s_mov_b32 s47, 0
    s_mov_b32 m0, s22
    s_nop 0
    buffer_load_dwordx4 v5, s[8:11], s20 offen lds
    buffer_load_dwordx4 v5, s[8:11], s20 offen offset:1024 lds
    buffer_load_dwordx4 v5, s[8:11], s20 offen offset:2048 lds
    buffer_load_dwordx4 v5, s[8:11], s20 offen offset:3072 lds
    s_sub_u32 s20, s20, 2
    s_add_u32 s22, s22, 4416
    s_mov_b32 m0, s22
    s_nop 0
    buffer_load_dwordx4 v5, s[8:11], s20 offen lds
    buffer_load_dwordx4 v5, s[8:11], s20 offen offset:1024 lds
    buffer_load_dwordx4 v5, s[8:11], s20 offen offset:2048 lds
    buffer_load_dwordx4 v5, s[8:11], s20 offen offset:3072 lds
    s_and_b32 s40, s2, 1
    s_mul_i32 s40, s40, 917504
    s_lshr_b32 s41, s2, 3
    s_mul_i32 s41, s41, 28672
    s_add_u32 s40, s40, s41
    s_mul_i32 s41, s3, 7168
    s_add_u32 s40, s40, s41
    s_add_u32 s40, s40, s47
    s_add_u32 s41, s40, 4096
    v_mov_b32 v32, 0
    v_mov_b32 v33, 0
    v_mov_b32 v34, 0
    v_mov_b32 v35, 0
    v_cmp_gt_u32 vcc, 36, v124
    s_and_saveexec_b64 s[26:27], vcc
    ds_write_b128 v3, v[32:35] offset:35328
    ds_write_b128 v3, v[32:35] offset:40192
    v_cmp_gt_u32 vcc, 8, v124
    s_and_b64 exec, exec, vcc
    v_mul_u32_u24 v36, 4416, v124
    ds_write_b64 v36, v[32:33] offset:4208
    ds_write_b64 v36, v[32:33] offset:4216
    ds_write_b64 v36, v[32:33] offset:4224
    s_mov_b64 exec, -1
    v_and_b32 v36, 15, v1
    v_lshrrev_b32 v37, 4, v1
    s_mul_i32 s25, s17, 4864
    s_add_u32 s25, s25, 35488
    s_lshl_b32 s26, s18, 6
    s_sub_u32 s25, s25, s26
    v_lshlrev_b32 v38, 5, v36
    v_lshl_add_u32 v38, v37, 4, v38
    v_add_u32 v38, s25, v38
    v_and_b32 v40, 3, v36
    v_lshrrev_b32 v41, 2, v36
    v_mul_u32_u24 v39, 4416, v40
    v_lshl_add_u32 v39, v37, 4, v39
    v_lshlrev_b32 v41, 3, v41
    v_sub_u32 v39, v39, v41
    s_mul_i32 s25, s17, 17664
    s_add_u32 s25, s25, 200
    s_sub_u32 s25, s25, s26
    v_add_u32 v39, s25, v39
    v_lshlrev_b32 v42, 5, v36
    v_lshl_add_u32 v42, v37, 3, v42
    s_lshl_b32 s25, s3, 12
    s_add_u32 s25, s25, 53248
    v_add_u32 v43, s25, v5
    s_xor_b32 s26, s3, 1
    s_lshl_b32 s26, s26, 12
    s_add_u32 s26, s26, 53248
    v_add_u32 v120, s26, v5
    s_mul_i32 s27, s17, 4864
    s_add_u32 s27, s27, 35904
    v_add_u32 v121, s27, v42
    s_lshl_b32 s27, s17, 12
    s_add_u32 s27, s27, 45056
    v_add_u32 v122, s27, v42
    v_lshrrev_b32 v40, 1, v37
    v_and_b32 v41, 1, v37
    v_lshlrev_b32 v6, 5, v36
    v_lshl_add_u32 v6, v40, 4, v6
    v_lshl_add_u32 v6, v41, 9, v6
    s_mul_i32 s35, s19, 4224
    s_add_u32 s35, s35, s32
    s_mov_b32 s28, 0x3b000000
    s_mov_b32 s29, 0x3b000000
    s_mov_b32 s42, 0x3727c5ac
    s_mov_b32 s43, 0x3727c5ac
    s_waitcnt vmcnt(10)
    v_pk_mul_f32 v[16:17], v[16:17], s[28:29]
    v_pk_mul_f32 v[18:19], v[18:19], s[28:29]
    v_pk_mul_f32 v[20:21], v[20:21], s[28:29]
    v_pk_mul_f32 v[22:23], v[22:23], s[28:29]
    v_pk_mul_f32 v[24:25], v[24:25], s[28:29]
    v_pk_mul_f32 v[26:27], v[26:27], s[28:29]
    v_pk_mul_f32 v[28:29], v[28:29], s[28:29]
    v_pk_mul_f32 v[30:31], v[30:31], s[28:29]
    v_fma_f32 v17, -v16, v16, v17
    v_fma_f32 v19, -v18, v18, v19
    v_cvt_pk_bf16_f32 v60, v16, v18
    v_max_f32 v17, 0, v17
    v_max_f32 v19, 0, v19
    v_fma_f32 v21, -v20, v20, v21
    v_fma_f32 v23, -v22, v22, v23
    v_cvt_pk_bf16_f32 v61, v20, v22
    v_max_f32 v21, 0, v21
    v_max_f32 v23, 0, v23
    v_fma_f32 v25, -v24, v24, v25
    v_fma_f32 v27, -v26, v26, v27
    v_cvt_pk_bf16_f32 v62, v24, v26
    v_max_f32 v25, 0, v25
    v_max_f32 v27, 0, v27
    v_fma_f32 v29, -v28, v28, v29
    v_fma_f32 v31, -v30, v30, v31
    v_cvt_pk_bf16_f32 v63, v28, v30
    v_max_f32 v29, 0, v29
    v_max_f32 v31, 0, v31
    v_cvt_pk_bf16_f32 v16, v17, v19
    v_lshlrev_b32 v44, 16, v60
    v_and_b32 v45, 0xffff0000, v60
    v_lshlrev_b32 v18, 16, v16
    v_and_b32 v19, 0xffff0000, v16
    v_pk_add_f32 v[18:19], v[18:19], s[42:43]
    v_cvt_pk_bf16_f32 v16, v18, v19
    v_lshlrev_b32 v18, 16, v16
    v_and_b32 v19, 0xffff0000, v16
    v_sqrt_f32 v18, v18
    v_sqrt_f32 v19, v19
    v_cvt_pk_bf16_f32 v20, v21, v23
    v_lshlrev_b32 v46, 16, v61
    v_and_b32 v47, 0xffff0000, v61
    v_lshlrev_b32 v22, 16, v20
    v_and_b32 v23, 0xffff0000, v20
    v_pk_add_f32 v[22:23], v[22:23], s[42:43]
    v_cvt_pk_bf16_f32 v20, v22, v23
    v_lshlrev_b32 v22, 16, v20
    v_and_b32 v23, 0xffff0000, v20
    v_sqrt_f32 v22, v22
    v_sqrt_f32 v23, v23
    v_cvt_pk_bf16_f32 v24, v25, v27
    v_lshlrev_b32 v48, 16, v62
    v_and_b32 v49, 0xffff0000, v62
    v_lshlrev_b32 v26, 16, v24
    v_and_b32 v27, 0xffff0000, v24
    v_pk_add_f32 v[26:27], v[26:27], s[42:43]
    v_cvt_pk_bf16_f32 v24, v26, v27
    v_lshlrev_b32 v26, 16, v24
    v_and_b32 v27, 0xffff0000, v24
    v_sqrt_f32 v26, v26
    v_sqrt_f32 v27, v27
    v_cvt_pk_bf16_f32 v28, v29, v31
    v_lshlrev_b32 v50, 16, v63
    v_and_b32 v51, 0xffff0000, v63
    v_lshlrev_b32 v30, 16, v28
    v_and_b32 v31, 0xffff0000, v28
    v_pk_add_f32 v[30:31], v[30:31], s[42:43]
    v_cvt_pk_bf16_f32 v28, v30, v31
    v_lshlrev_b32 v30, 16, v28
    v_and_b32 v31, 0xffff0000, v28
    v_sqrt_f32 v30, v30
    v_sqrt_f32 v31, v31
    v_cvt_pk_bf16_f32 v16, v18, v19
    v_lshlrev_b32 v18, 16, v16
    v_and_b32 v19, 0xffff0000, v16
    v_rcp_f32 v52, v18
    v_rcp_f32 v53, v19
    v_cvt_pk_bf16_f32 v20, v22, v23
    v_lshlrev_b32 v22, 16, v20
    v_and_b32 v23, 0xffff0000, v20
    v_rcp_f32 v54, v22
    v_rcp_f32 v55, v23
    v_cvt_pk_bf16_f32 v24, v26, v27
    v_lshlrev_b32 v26, 16, v24
    v_and_b32 v27, 0xffff0000, v24
    v_rcp_f32 v56, v26
    v_rcp_f32 v57, v27
    v_cvt_pk_bf16_f32 v28, v30, v31
    v_lshlrev_b32 v30, 16, v28
    v_and_b32 v31, 0xffff0000, v28
    v_rcp_f32 v58, v30
    v_rcp_f32 v59, v31
    s_waitcnt vmcnt(8)
    ds_write_b128 v3, v[8:11] offset:45056
    ds_write_b128 v3, v[12:15] offset:49152
    v_lshlrev_b32 v16, 16, v8
    v_and_b32 v17, 0xffff0000, v8
    v_pk_add_f32 v[16:17], v[16:17], v[44:45] neg_lo:[0,1] neg_hi:[0,1]
    v_cvt_pk_bf16_f32 v60, v16, v17
    v_lshlrev_b32 v18, 16, v9
    v_and_b32 v19, 0xffff0000, v9
    v_pk_add_f32 v[18:19], v[18:19], v[46:47] neg_lo:[0,1] neg_hi:[0,1]
    v_cvt_pk_bf16_f32 v61, v18, v19
    v_lshlrev_b32 v20, 16, v10
    v_and_b32 v21, 0xffff0000, v10
    v_pk_add_f32 v[20:21], v[20:21], v[48:49] neg_lo:[0,1] neg_hi:[0,1]
    v_cvt_pk_bf16_f32 v62, v20, v21
    v_lshlrev_b32 v22, 16, v11
    v_and_b32 v23, 0xffff0000, v11
    v_pk_add_f32 v[22:23], v[22:23], v[50:51] neg_lo:[0,1] neg_hi:[0,1]
    v_cvt_pk_bf16_f32 v63, v22, v23
    v_lshlrev_b32 v16, 16, v60
    v_and_b32 v17, 0xffff0000, v60
    v_pk_mul_f32 v[16:17], v[16:17], v[52:53]
    v_cvt_pk_bf16_f32 v64, v16, v17
    v_lshlrev_b32 v18, 16, v61
    v_and_b32 v19, 0xffff0000, v61
    v_pk_mul_f32 v[18:19], v[18:19], v[54:55]
    v_cvt_pk_bf16_f32 v65, v18, v19
    v_lshlrev_b32 v20, 16, v62
    v_and_b32 v21, 0xffff0000, v62
    v_pk_mul_f32 v[20:21], v[20:21], v[56:57]
    v_cvt_pk_bf16_f32 v66, v20, v21
    v_lshlrev_b32 v22, 16, v63
    v_and_b32 v23, 0xffff0000, v63
    v_pk_mul_f32 v[22:23], v[22:23], v[58:59]
    v_cvt_pk_bf16_f32 v67, v22, v23
    ds_write_b128 v3, v[64:67] offset:35904
    v_lshlrev_b32 v16, 16, v12
    v_and_b32 v17, 0xffff0000, v12
    v_pk_add_f32 v[16:17], v[16:17], v[44:45] neg_lo:[0,1] neg_hi:[0,1]
    v_cvt_pk_bf16_f32 v60, v16, v17
    v_lshlrev_b32 v18, 16, v13
    v_and_b32 v19, 0xffff0000, v13
    v_pk_add_f32 v[18:19], v[18:19], v[46:47] neg_lo:[0,1] neg_hi:[0,1]
    v_cvt_pk_bf16_f32 v61, v18, v19
    v_lshlrev_b32 v20, 16, v14
    v_and_b32 v21, 0xffff0000, v14
    v_pk_add_f32 v[20:21], v[20:21], v[48:49] neg_lo:[0,1] neg_hi:[0,1]
    v_cvt_pk_bf16_f32 v62, v20, v21
    v_lshlrev_b32 v22, 16, v15
    v_and_b32 v23, 0xffff0000, v15
    v_pk_add_f32 v[22:23], v[22:23], v[50:51] neg_lo:[0,1] neg_hi:[0,1]
    v_cvt_pk_bf16_f32 v63, v22, v23
    v_lshlrev_b32 v16, 16, v60
    v_and_b32 v17, 0xffff0000, v60
    v_pk_mul_f32 v[16:17], v[16:17], v[52:53]
    v_cvt_pk_bf16_f32 v68, v16, v17
    v_lshlrev_b32 v18, 16, v61
    v_and_b32 v19, 0xffff0000, v61
    v_pk_mul_f32 v[18:19], v[18:19], v[54:55]
    v_cvt_pk_bf16_f32 v69, v18, v19
    v_lshlrev_b32 v20, 16, v62
    v_and_b32 v21, 0xffff0000, v62
    v_pk_mul_f32 v[20:21], v[20:21], v[56:57]
    v_cvt_pk_bf16_f32 v70, v20, v21
    v_lshlrev_b32 v22, 16, v63
    v_and_b32 v23, 0xffff0000, v63
    v_pk_mul_f32 v[22:23], v[22:23], v[58:59]
    v_cvt_pk_bf16_f32 v71, v22, v23
    ds_write_b128 v3, v[68:71] offset:40768
    s_waitcnt vmcnt(0)
    s_waitcnt lgkmcnt(0)
    s_barrier
    s_lshl_b32 s30, s16, 16
    s_and_b32 s31, s16, 0xffff0000
    s_cmp_eq_u32 s17, 0
    s_cselect_b32 s30, s30, s31
    s_mov_b32 s31, s30
    ds_read_b64 v[96:97], v39 offset:3968
    ds_read_b64 v[98:99], v39 offset:3976
    ds_read_b128 a[12:15], v38 offset:384
    ds_read_b128 a[28:31], v38 offset:896
    ds_read_b128 a[44:47], v38 offset:1408
    ds_read_b128 a[60:63], v38 offset:1920
    ds_read_b128 a[76:79], v38 offset:2432
    ds_read_b128 a[92:95], v38 offset:2944
    ds_read_b128 a[108:111], v38 offset:3456
    ds_read_b128 a[124:127], v38 offset:3968
    ds_read_b64 v[100:101], v39 offset:3840
    ds_read_b64 v[102:103], v39 offset:3848
    s_waitcnt lgkmcnt(9)
    v_mfma_f32_16x16x32_bf16 v[64:67], v[96:99], a[12:15], 0
    ds_read_b128 a[8:11], v38 offset:256
    ds_read_b128 a[24:27], v38 offset:768
    s_waitcnt lgkmcnt(10)
    v_mfma_f32_16x16x32_bf16 v[68:71], v[96:99], a[28:31], 0
    ds_read_b128 a[40:43], v38 offset:1280
    s_waitcnt lgkmcnt(10)
    v_mfma_f32_16x16x32_bf16 v[72:75], v[96:99], a[44:47], 0
    ds_read_b128 a[56:59], v38 offset:1792
    s_waitcnt lgkmcnt(10)
    v_mfma_f32_16x16x32_bf16 v[76:79], v[96:99], a[60:63], 0
    ds_read_b128 a[72:75], v38 offset:2304
    s_waitcnt lgkmcnt(10)
    v_mfma_f32_16x16x32_bf16 v[80:83], v[96:99], a[76:79], 0
    ds_read_b128 a[88:91], v38 offset:2816
    s_waitcnt lgkmcnt(10)
    v_mfma_f32_16x16x32_bf16 v[84:87], v[96:99], a[92:95], 0
    ds_read_b128 a[104:107], v38 offset:3328
    s_waitcnt lgkmcnt(10)
    v_mfma_f32_16x16x32_bf16 v[88:91], v[96:99], a[108:111], 0
    ds_read_b128 a[120:123], v38 offset:3840
    s_waitcnt lgkmcnt(10)
    v_mfma_f32_16x16x32_bf16 v[92:95], v[96:99], a[124:127], 0
    ds_read_b64 v[104:105], v39 offset:3712
    ds_read_b64 v[106:107], v39 offset:3720
    s_waitcnt lgkmcnt(9)
    v_mfma_f32_16x16x32_bf16 v[64:67], v[100:103], a[8:11], v[64:67]
    ds_read_b128 a[4:7], v38 offset:128
    ds_read_b128 a[20:23], v38 offset:640
    s_waitcnt lgkmcnt(10)
    v_mfma_f32_16x16x32_bf16 v[68:71], v[100:103], a[24:27], v[68:71]
    ds_read_b128 a[36:39], v38 offset:1152
    s_waitcnt lgkmcnt(10)
    v_mfma_f32_16x16x32_bf16 v[72:75], v[100:103], a[40:43], v[72:75]
    ds_read_b128 a[52:55], v38 offset:1664
    s_waitcnt lgkmcnt(10)
    v_mfma_f32_16x16x32_bf16 v[76:79], v[100:103], a[56:59], v[76:79]
    ds_read_b128 a[68:71], v38 offset:2176
    s_waitcnt lgkmcnt(10)
    v_mfma_f32_16x16x32_bf16 v[80:83], v[100:103], a[72:75], v[80:83]
    ds_read_b128 a[84:87], v38 offset:2688
    s_waitcnt lgkmcnt(10)
    v_mfma_f32_16x16x32_bf16 v[84:87], v[100:103], a[88:91], v[84:87]
    ds_read_b128 a[100:103], v38 offset:3200
    s_waitcnt lgkmcnt(10)
    v_mfma_f32_16x16x32_bf16 v[88:91], v[100:103], a[104:107], v[88:91]
    ds_read_b128 a[116:119], v38 offset:3712
    s_waitcnt lgkmcnt(10)
    v_mfma_f32_16x16x32_bf16 v[92:95], v[100:103], a[120:123], v[92:95]
    ds_read_b64 v[108:109], v39 offset:3584
    ds_read_b64 v[110:111], v39 offset:3592
    s_waitcnt lgkmcnt(9)
    v_mfma_f32_16x16x32_bf16 v[64:67], v[104:107], a[4:7], v[64:67]
    ds_read_b128 a[0:3], v38 offset:0
    ds_read_b128 a[16:19], v38 offset:512
    s_waitcnt lgkmcnt(10)
    v_mfma_f32_16x16x32_bf16 v[68:71], v[104:107], a[20:23], v[68:71]
    ds_read_b128 a[32:35], v38 offset:1024
    s_waitcnt lgkmcnt(10)
    v_mfma_f32_16x16x32_bf16 v[72:75], v[104:107], a[36:39], v[72:75]
    ds_read_b128 a[48:51], v38 offset:1536
    s_waitcnt lgkmcnt(10)
    v_mfma_f32_16x16x32_bf16 v[76:79], v[104:107], a[52:55], v[76:79]
    ds_read_b128 a[64:67], v38 offset:2048
    s_waitcnt lgkmcnt(10)
    v_mfma_f32_16x16x32_bf16 v[80:83], v[104:107], a[68:71], v[80:83]
    ds_read_b128 a[80:83], v38 offset:2560
    s_waitcnt lgkmcnt(10)
    v_mfma_f32_16x16x32_bf16 v[84:87], v[104:107], a[84:87], v[84:87]
    ds_read_b128 a[96:99], v38 offset:3072
    s_waitcnt lgkmcnt(10)
    v_mfma_f32_16x16x32_bf16 v[88:91], v[104:107], a[100:103], v[88:91]
    ds_read_b128 a[112:115], v38 offset:3584
    s_waitcnt lgkmcnt(10)
    v_mfma_f32_16x16x32_bf16 v[92:95], v[104:107], a[116:119], v[92:95]
    ds_read_b64 v[112:113], v39 offset:3456
    ds_read_b64 v[114:115], v39 offset:3464
    s_waitcnt lgkmcnt(9)
    v_mfma_f32_16x16x32_bf16 v[64:67], v[108:111], a[0:3], v[64:67]
    ds_read_b64 v[116:117], v39 offset:0
    ds_read_b64 v[118:119], v39 offset:8
    s_waitcnt lgkmcnt(10)
    v_mfma_f32_16x16x32_bf16 v[68:71], v[108:111], a[16:19], v[68:71]
    ds_read_b64 v[96:97], v39 offset:3328
    ds_read_b64 v[98:99], v39 offset:3336
    s_waitcnt lgkmcnt(11)
    v_mfma_f32_16x16x32_bf16 v[72:75], v[108:111], a[32:35], v[72:75]
    ds_read_b64 v[100:101], v39 offset:128
    ds_read_b64 v[102:103], v39 offset:136
    s_waitcnt lgkmcnt(12)
    v_mfma_f32_16x16x32_bf16 v[76:79], v[108:111], a[48:51], v[76:79]
    s_waitcnt lgkmcnt(11)
    v_mfma_f32_16x16x32_bf16 v[80:83], v[108:111], a[64:67], v[80:83]
    s_waitcnt lgkmcnt(10)
    v_mfma_f32_16x16x32_bf16 v[84:87], v[108:111], a[80:83], v[84:87]
    s_waitcnt lgkmcnt(9)
    v_mfma_f32_16x16x32_bf16 v[88:91], v[108:111], a[96:99], v[88:91]
    s_waitcnt lgkmcnt(8)
    v_mfma_f32_16x16x32_bf16 v[92:95], v[108:111], a[112:115], v[92:95]
    s_waitcnt lgkmcnt(6)
    v_mfma_f32_16x16x32_bf16 v[68:71], v[112:115], a[12:15], v[68:71]
    ds_read_b64 v[104:105], v39 offset:3200
    ds_read_b64 v[106:107], v39 offset:3208
    v_mfma_f32_16x16x32_bf16 v[72:75], v[112:115], a[28:31], v[72:75]
    v_mfma_f32_16x16x32_bf16 v[76:79], v[112:115], a[44:47], v[76:79]
    v_mfma_f32_16x16x32_bf16 v[80:83], v[112:115], a[60:63], v[80:83]
    v_mfma_f32_16x16x32_bf16 v[84:87], v[112:115], a[76:79], v[84:87]
    v_mfma_f32_16x16x32_bf16 v[88:91], v[112:115], a[92:95], v[88:91]
    v_mfma_f32_16x16x32_bf16 v[92:95], v[112:115], a[108:111], v[92:95]
    s_waitcnt lgkmcnt(6)
    v_mfma_f32_16x16x32_bf16 v[92:95], v[116:119], a[0:3], v[92:95]
    ds_read_b64 v[108:109], v39 offset:256
    ds_read_b64 v[110:111], v39 offset:264
    s_waitcnt lgkmcnt(6)
    v_mfma_f32_16x16x32_bf16 v[68:71], v[96:99], a[8:11], v[68:71]
    ds_read_b64 v[112:113], v39 offset:3072
    ds_read_b64 v[114:115], v39 offset:3080
    v_mfma_f32_16x16x32_bf16 v[72:75], v[96:99], a[24:27], v[72:75]
    v_mfma_f32_16x16x32_bf16 v[76:79], v[96:99], a[40:43], v[76:79]
    v_mfma_f32_16x16x32_bf16 v[80:83], v[96:99], a[56:59], v[80:83]
    v_mfma_f32_16x16x32_bf16 v[84:87], v[96:99], a[72:75], v[84:87]
    v_mfma_f32_16x16x32_bf16 v[88:91], v[96:99], a[88:91], v[88:91]
    v_mfma_f32_16x16x32_bf16 v[92:95], v[96:99], a[104:107], v[92:95]
    s_waitcnt lgkmcnt(6)
    v_mfma_f32_16x16x32_bf16 v[92:95], v[100:103], a[4:7], v[92:95]
    ds_read_b64 v[116:117], v39 offset:384
    ds_read_b64 v[118:119], v39 offset:392
    s_waitcnt lgkmcnt(6)
    v_mfma_f32_16x16x32_bf16 v[68:71], v[104:107], a[4:7], v[68:71]
    ds_read_b64 v[96:97], v39 offset:2944
    ds_read_b64 v[98:99], v39 offset:2952
    v_mfma_f32_16x16x32_bf16 v[72:75], v[104:107], a[20:23], v[72:75]
    v_mfma_f32_16x16x32_bf16 v[76:79], v[104:107], a[36:39], v[76:79]
    v_mfma_f32_16x16x32_bf16 v[80:83], v[104:107], a[52:55], v[80:83]
    v_mfma_f32_16x16x32_bf16 v[84:87], v[104:107], a[68:71], v[84:87]
    v_mfma_f32_16x16x32_bf16 v[88:91], v[104:107], a[84:87], v[88:91]
    v_mfma_f32_16x16x32_bf16 v[92:95], v[104:107], a[100:103], v[92:95]
    s_waitcnt lgkmcnt(6)
    v_mfma_f32_16x16x32_bf16 v[92:95], v[108:111], a[8:11], v[92:95]
    ds_read_b64 v[100:101], v39 offset:512
    ds_read_b64 v[102:103], v39 offset:520
    s_waitcnt lgkmcnt(6)
    v_mfma_f32_16x16x32_bf16 v[68:71], v[112:115], a[0:3], v[68:71]
    ds_read_b64 v[104:105], v39 offset:2816
    ds_read_b64 v[106:107], v39 offset:2824
    v_mfma_f32_16x16x32_bf16 v[72:75], v[112:115], a[16:19], v[72:75]
    v_mfma_f32_16x16x32_bf16 v[76:79], v[112:115], a[32:35], v[76:79]
    v_mfma_f32_16x16x32_bf16 v[80:83], v[112:115], a[48:51], v[80:83]
    v_mfma_f32_16x16x32_bf16 v[84:87], v[112:115], a[64:67], v[84:87]
    v_mfma_f32_16x16x32_bf16 v[88:91], v[112:115], a[80:83], v[88:91]
    v_mfma_f32_16x16x32_bf16 v[92:95], v[112:115], a[96:99], v[92:95]
    s_waitcnt lgkmcnt(6)
    v_mfma_f32_16x16x32_bf16 v[92:95], v[116:119], a[12:15], v[92:95]
    ds_read_b64 v[108:109], v39 offset:640
    ds_read_b64 v[110:111], v39 offset:648
    s_waitcnt lgkmcnt(6)
    v_mfma_f32_16x16x32_bf16 v[72:75], v[96:99], a[12:15], v[72:75]
    ds_read_b64 v[112:113], v39 offset:2688
    ds_read_b64 v[114:115], v39 offset:2696
    v_mfma_f32_16x16x32_bf16 v[76:79], v[96:99], a[28:31], v[76:79]
    v_mfma_f32_16x16x32_bf16 v[80:83], v[96:99], a[44:47], v[80:83]
    v_mfma_f32_16x16x32_bf16 v[84:87], v[96:99], a[60:63], v[84:87]
    v_mfma_f32_16x16x32_bf16 v[88:91], v[96:99], a[76:79], v[88:91]
    v_mfma_f32_16x16x32_bf16 v[92:95], v[96:99], a[92:95], v[92:95]
    s_waitcnt lgkmcnt(6)
    v_mfma_f32_16x16x32_bf16 v[88:91], v[100:103], a[0:3], v[88:91]
    ds_read_b64 v[116:117], v39 offset:768
    ds_read_b64 v[118:119], v39 offset:776
    v_mfma_f32_16x16x32_bf16 v[92:95], v[100:103], a[16:19], v[92:95]
    s_waitcnt lgkmcnt(6)
    v_mfma_f32_16x16x32_bf16 v[72:75], v[104:107], a[8:11], v[72:75]
    ds_read_b64 v[96:97], v39 offset:2560
    ds_read_b64 v[98:99], v39 offset:2568
    v_mfma_f32_16x16x32_bf16 v[76:79], v[104:107], a[24:27], v[76:79]
    v_mfma_f32_16x16x32_bf16 v[80:83], v[104:107], a[40:43], v[80:83]
    v_mfma_f32_16x16x32_bf16 v[84:87], v[104:107], a[56:59], v[84:87]
    v_mfma_f32_16x16x32_bf16 v[88:91], v[104:107], a[72:75], v[88:91]
    v_mfma_f32_16x16x32_bf16 v[92:95], v[104:107], a[88:91], v[92:95]
    s_waitcnt lgkmcnt(6)
    v_mfma_f32_16x16x32_bf16 v[88:91], v[108:111], a[4:7], v[88:91]
    ds_read_b64 v[100:101], v39 offset:896
    ds_read_b64 v[102:103], v39 offset:904
    v_mfma_f32_16x16x32_bf16 v[92:95], v[108:111], a[20:23], v[92:95]
    s_waitcnt lgkmcnt(6)
    v_mfma_f32_16x16x32_bf16 v[72:75], v[112:115], a[4:7], v[72:75]
    ds_read_b64 v[104:105], v39 offset:2432
    ds_read_b64 v[106:107], v39 offset:2440
    v_mfma_f32_16x16x32_bf16 v[76:79], v[112:115], a[20:23], v[76:79]
    v_mfma_f32_16x16x32_bf16 v[80:83], v[112:115], a[36:39], v[80:83]
    v_mfma_f32_16x16x32_bf16 v[84:87], v[112:115], a[52:55], v[84:87]
    v_mfma_f32_16x16x32_bf16 v[88:91], v[112:115], a[68:71], v[88:91]
    v_mfma_f32_16x16x32_bf16 v[92:95], v[112:115], a[84:87], v[92:95]
    s_waitcnt lgkmcnt(6)
    v_mfma_f32_16x16x32_bf16 v[88:91], v[116:119], a[8:11], v[88:91]
    ds_read_b64 v[108:109], v39 offset:1024
    ds_read_b64 v[110:111], v39 offset:1032
    v_mfma_f32_16x16x32_bf16 v[92:95], v[116:119], a[24:27], v[92:95]
    s_waitcnt lgkmcnt(6)
    v_mfma_f32_16x16x32_bf16 v[72:75], v[96:99], a[0:3], v[72:75]
    ds_read_b64 v[112:113], v39 offset:2304
    ds_read_b64 v[114:115], v39 offset:2312
    v_mfma_f32_16x16x32_bf16 v[76:79], v[96:99], a[16:19], v[76:79]
    v_mfma_f32_16x16x32_bf16 v[80:83], v[96:99], a[32:35], v[80:83]
    v_mfma_f32_16x16x32_bf16 v[84:87], v[96:99], a[48:51], v[84:87]
    v_mfma_f32_16x16x32_bf16 v[88:91], v[96:99], a[64:67], v[88:91]
    v_mfma_f32_16x16x32_bf16 v[92:95], v[96:99], a[80:83], v[92:95]
    s_waitcnt lgkmcnt(6)
    v_mfma_f32_16x16x32_bf16 v[88:91], v[100:103], a[12:15], v[88:91]
    ds_read_b64 v[116:117], v39 offset:1152
    ds_read_b64 v[118:119], v39 offset:1160
    v_mfma_f32_16x16x32_bf16 v[92:95], v[100:103], a[28:31], v[92:95]
    s_waitcnt lgkmcnt(6)
    v_mfma_f32_16x16x32_bf16 v[76:79], v[104:107], a[12:15], v[76:79]
    ds_read_b64 v[96:97], v39 offset:2176
    ds_read_b64 v[98:99], v39 offset:2184
    v_mfma_f32_16x16x32_bf16 v[80:83], v[104:107], a[28:31], v[80:83]
    v_mfma_f32_16x16x32_bf16 v[84:87], v[104:107], a[44:47], v[84:87]
    v_mfma_f32_16x16x32_bf16 v[88:91], v[104:107], a[60:63], v[88:91]
    v_mfma_f32_16x16x32_bf16 v[92:95], v[104:107], a[76:79], v[92:95]
    s_waitcnt lgkmcnt(6)
    v_mfma_f32_16x16x32_bf16 v[84:87], v[108:111], a[0:3], v[84:87]
    ds_read_b64 v[100:101], v39 offset:1280
    ds_read_b64 v[102:103], v39 offset:1288
    v_mfma_f32_16x16x32_bf16 v[88:91], v[108:111], a[16:19], v[88:91]
    v_mfma_f32_16x16x32_bf16 v[92:95], v[108:111], a[32:35], v[92:95]
    s_waitcnt lgkmcnt(6)
    v_mfma_f32_16x16x32_bf16 v[76:79], v[112:115], a[8:11], v[76:79]
    ds_read_b64 v[104:105], v39 offset:2048
    ds_read_b64 v[106:107], v39 offset:2056
    v_mfma_f32_16x16x32_bf16 v[80:83], v[112:115], a[24:27], v[80:83]
    v_mfma_f32_16x16x32_bf16 v[84:87], v[112:115], a[40:43], v[84:87]
    v_mfma_f32_16x16x32_bf16 v[88:91], v[112:115], a[56:59], v[88:91]
    v_mfma_f32_16x16x32_bf16 v[92:95], v[112:115], a[72:75], v[92:95]
    s_waitcnt lgkmcnt(6)
    v_mfma_f32_16x16x32_bf16 v[84:87], v[116:119], a[4:7], v[84:87]
    ds_read_b64 v[108:109], v39 offset:1408
    ds_read_b64 v[110:111], v39 offset:1416
    v_mfma_f32_16x16x32_bf16 v[88:91], v[116:119], a[20:23], v[88:91]
    v_mfma_f32_16x16x32_bf16 v[92:95], v[116:119], a[36:39], v[92:95]
    s_waitcnt lgkmcnt(6)
    v_mfma_f32_16x16x32_bf16 v[76:79], v[96:99], a[4:7], v[76:79]
    ds_read_b64 v[112:113], v39 offset:1920
    ds_read_b64 v[114:115], v39 offset:1928
    v_mfma_f32_16x16x32_bf16 v[80:83], v[96:99], a[20:23], v[80:83]
    v_mfma_f32_16x16x32_bf16 v[84:87], v[96:99], a[36:39], v[84:87]
    v_mfma_f32_16x16x32_bf16 v[88:91], v[96:99], a[52:55], v[88:91]
    v_mfma_f32_16x16x32_bf16 v[92:95], v[96:99], a[68:71], v[92:95]
    s_waitcnt lgkmcnt(6)
    v_mfma_f32_16x16x32_bf16 v[84:87], v[100:103], a[8:11], v[84:87]
    ds_read_b64 v[116:117], v39 offset:1536
    ds_read_b64 v[118:119], v39 offset:1544
    v_mfma_f32_16x16x32_bf16 v[88:91], v[100:103], a[24:27], v[88:91]
    v_mfma_f32_16x16x32_bf16 v[92:95], v[100:103], a[40:43], v[92:95]
    s_waitcnt lgkmcnt(6)
    v_mfma_f32_16x16x32_bf16 v[76:79], v[104:107], a[0:3], v[76:79]
    ds_read_b64 v[96:97], v39 offset:1792
    ds_read_b64 v[98:99], v39 offset:1800
    v_mfma_f32_16x16x32_bf16 v[80:83], v[104:107], a[16:19], v[80:83]
    v_mfma_f32_16x16x32_bf16 v[84:87], v[104:107], a[32:35], v[84:87]
    v_mfma_f32_16x16x32_bf16 v[88:91], v[104:107], a[48:51], v[88:91]
    v_mfma_f32_16x16x32_bf16 v[92:95], v[104:107], a[64:67], v[92:95]
    s_waitcnt lgkmcnt(6)
    v_mfma_f32_16x16x32_bf16 v[84:87], v[108:111], a[12:15], v[84:87]
    ds_read_b64 v[100:101], v39 offset:1664
    ds_read_b64 v[102:103], v39 offset:1672
    v_mfma_f32_16x16x32_bf16 v[88:91], v[108:111], a[28:31], v[88:91]
    v_mfma_f32_16x16x32_bf16 v[92:95], v[108:111], a[44:47], v[92:95]
    s_waitcnt lgkmcnt(6)
    v_mfma_f32_16x16x32_bf16 v[80:83], v[112:115], a[12:15], v[80:83]
    v_mfma_f32_16x16x32_bf16 v[84:87], v[112:115], a[28:31], v[84:87]
    v_mfma_f32_16x16x32_bf16 v[88:91], v[112:115], a[44:47], v[88:91]
    v_mfma_f32_16x16x32_bf16 v[92:95], v[112:115], a[60:63], v[92:95]
    s_waitcnt lgkmcnt(4)
    v_mfma_f32_16x16x32_bf16 v[80:83], v[116:119], a[0:3], v[80:83]
    v_mfma_f32_16x16x32_bf16 v[84:87], v[116:119], a[16:19], v[84:87]
    v_mfma_f32_16x16x32_bf16 v[88:91], v[116:119], a[32:35], v[88:91]
    v_mfma_f32_16x16x32_bf16 v[92:95], v[116:119], a[48:51], v[92:95]
    s_waitcnt lgkmcnt(2)
    v_mfma_f32_16x16x32_bf16 v[80:83], v[96:99], a[8:11], v[80:83]
    v_mfma_f32_16x16x32_bf16 v[84:87], v[96:99], a[24:27], v[84:87]
    v_mfma_f32_16x16x32_bf16 v[88:91], v[96:99], a[40:43], v[88:91]
    v_mfma_f32_16x16x32_bf16 v[92:95], v[96:99], a[56:59], v[92:95]
    s_waitcnt lgkmcnt(0)
    v_mfma_f32_16x16x32_bf16 v[80:83], v[100:103], a[4:7], v[80:83]
    v_mfma_f32_16x16x32_bf16 v[84:87], v[100:103], a[20:23], v[84:87]
    v_mfma_f32_16x16x32_bf16 v[88:91], v[100:103], a[36:39], v[88:91]
    v_mfma_f32_16x16x32_bf16 v[92:95], v[100:103], a[52:55], v[92:95]
    s_cmp_eq_u32 s18, 0
    s_cbranch_scc0 Lcv_ep1
    ds_read_b64 v[8:9], v121 offset:0
    ds_read_b64 v[10:11], v121 offset:512
    ds_read_b64 v[12:13], v121 offset:1024
    ds_read_b64 v[14:15], v121 offset:1536
    ds_read_b64 v[16:17], v122 offset:0
    ds_read_b64 v[18:19], v122 offset:512
    ds_read_b64 v[20:21], v122 offset:1024
    ds_read_b64 v[22:23], v122 offset:1536
    ds_write_b128 v43, v[80:83] offset:0
    ds_write_b128 v43, v[84:87] offset:1024
    ds_write_b128 v43, v[88:91] offset:2048
    ds_write_b128 v43, v[92:95] offset:3072
    s_waitcnt lgkmcnt(8)
    v_lshlrev_b32 v44, 16, v8
    v_and_b32 v45, 0xffff0000, v8
    v_pk_mul_f32 v[44:45], v[44:45], s[30:31]
    v_cvt_pk_bf16_f32 v8, v44, v45
    v_lshlrev_b32 v46, 16, v9
    v_and_b32 v47, 0xffff0000, v9
    v_pk_mul_f32 v[46:47], v[46:47], s[30:31]
    v_cvt_pk_bf16_f32 v9, v46, v47
    v_lshlrev_b32 v48, 16, v10
    v_and_b32 v49, 0xffff0000, v10
    v_pk_mul_f32 v[48:49], v[48:49], s[30:31]
    v_cvt_pk_bf16_f32 v10, v48, v49
    v_lshlrev_b32 v50, 16, v11
    v_and_b32 v51, 0xffff0000, v11
    v_pk_mul_f32 v[50:51], v[50:51], s[30:31]
    v_cvt_pk_bf16_f32 v11, v50, v51
    v_lshlrev_b32 v52, 16, v12
    v_and_b32 v53, 0xffff0000, v12
    v_pk_mul_f32 v[52:53], v[52:53], s[30:31]
    v_cvt_pk_bf16_f32 v12, v52, v53
    v_lshlrev_b32 v54, 16, v13
    v_and_b32 v55, 0xffff0000, v13
    v_pk_mul_f32 v[54:55], v[54:55], s[30:31]
    v_cvt_pk_bf16_f32 v13, v54, v55
    v_lshlrev_b32 v56, 16, v14
    v_and_b32 v57, 0xffff0000, v14
    v_pk_mul_f32 v[56:57], v[56:57], s[30:31]
    v_cvt_pk_bf16_f32 v14, v56, v57
    v_lshlrev_b32 v58, 16, v15
    v_and_b32 v59, 0xffff0000, v15
    v_pk_mul_f32 v[58:59], v[58:59], s[30:31]
    v_cvt_pk_bf16_f32 v15, v58, v59
    s_waitcnt lgkmcnt(0)
    s_barrier
    ds_read_b128 v[80:83], v120 offset:0
    ds_read_b128 v[84:87], v120 offset:1024
    ds_read_b128 v[88:91], v120 offset:2048
    ds_read_b128 v[92:95], v120 offset:3072
    v_lshlrev_b32 v44, 16, v8
    v_and_b32 v45, 0xffff0000, v8
    v_lshlrev_b32 v96, 16, v16
    v_and_b32 v97, 0xffff0000, v16
    v_lshlrev_b32 v46, 16, v9
    v_and_b32 v47, 0xffff0000, v9
    v_lshlrev_b32 v98, 16, v17
    v_and_b32 v99, 0xffff0000, v17
    v_lshlrev_b32 v48, 16, v10
    v_and_b32 v49, 0xffff0000, v10
    v_lshlrev_b32 v100, 16, v18
    v_and_b32 v101, 0xffff0000, v18
    v_lshlrev_b32 v50, 16, v11
    v_and_b32 v51, 0xffff0000, v11
    v_lshlrev_b32 v102, 16, v19
    v_and_b32 v103, 0xffff0000, v19
    v_lshlrev_b32 v52, 16, v12
    v_and_b32 v53, 0xffff0000, v12
    v_lshlrev_b32 v104, 16, v20
    v_and_b32 v105, 0xffff0000, v20
    v_lshlrev_b32 v54, 16, v13
    v_and_b32 v55, 0xffff0000, v13
    v_lshlrev_b32 v106, 16, v21
    v_and_b32 v107, 0xffff0000, v21
    v_lshlrev_b32 v56, 16, v14
    v_and_b32 v57, 0xffff0000, v14
    v_lshlrev_b32 v108, 16, v22
    v_and_b32 v109, 0xffff0000, v22
    v_lshlrev_b32 v58, 16, v15
    v_and_b32 v59, 0xffff0000, v15
    v_lshlrev_b32 v110, 16, v23
    v_and_b32 v111, 0xffff0000, v23
    s_waitcnt lgkmcnt(2)
    v_pk_add_f32 v[64:65], v[64:65], v[80:81]
    v_pk_add_f32 v[66:67], v[66:67], v[82:83]
    v_pk_add_f32 v[68:69], v[68:69], v[84:85]
    v_pk_add_f32 v[70:71], v[70:71], v[86:87]
    v_cvt_pk_bf16_f32 v24, v64, v65
    v_cvt_pk_bf16_f32 v25, v66, v67
    v_cvt_pk_bf16_f32 v26, v68, v69
    v_cvt_pk_bf16_f32 v27, v70, v71
    v_lshlrev_b32 v64, 16, v24
    v_and_b32 v65, 0xffff0000, v24
    v_lshlrev_b32 v66, 16, v25
    v_and_b32 v67, 0xffff0000, v25
    v_lshlrev_b32 v68, 16, v26
    v_and_b32 v69, 0xffff0000, v26
    v_lshlrev_b32 v70, 16, v27
    v_and_b32 v71, 0xffff0000, v27
    v_pk_add_f32 v[64:65], v[64:65], v[44:45]
    v_pk_add_f32 v[66:67], v[66:67], v[46:47]
    v_pk_add_f32 v[68:69], v[68:69], v[48:49]
    v_pk_add_f32 v[70:71], v[70:71], v[50:51]
    v_cvt_pk_bf16_f32 v24, v64, v65
    v_cvt_pk_bf16_f32 v25, v66, v67
    v_cvt_pk_bf16_f32 v26, v68, v69
    v_cvt_pk_bf16_f32 v27, v70, v71
    v_lshlrev_b32 v64, 16, v24
    v_and_b32 v65, 0xffff0000, v24
    v_lshlrev_b32 v66, 16, v25
    v_and_b32 v67, 0xffff0000, v25
    v_lshlrev_b32 v68, 16, v26
    v_and_b32 v69, 0xffff0000, v26
    v_lshlrev_b32 v70, 16, v27
    v_and_b32 v71, 0xffff0000, v27
    v_pk_add_f32 v[64:65], v[64:65], v[96:97]
    v_pk_add_f32 v[66:67], v[66:67], v[98:99]
    v_pk_add_f32 v[68:69], v[68:69], v[100:101]
    v_pk_add_f32 v[70:71], v[70:71], v[102:103]
    v_cvt_pk_bf16_f32 v112, v64, v65
    v_cvt_pk_bf16_f32 v113, v66, v67
    v_cvt_pk_bf16_f32 v114, v68, v69
    v_cvt_pk_bf16_f32 v115, v70, v71
    s_nop 1
    v_permlane16_swap_b32 v112, v114
    v_permlane16_swap_b32 v113, v115
    buffer_store_dwordx4 v[112:115], v6, s[8:11], s35 offen offset:0 sc1
    s_waitcnt lgkmcnt(0)
    v_pk_add_f32 v[72:73], v[72:73], v[88:89]
    v_pk_add_f32 v[74:75], v[74:75], v[90:91]
    v_pk_add_f32 v[76:77], v[76:77], v[92:93]
    v_pk_add_f32 v[78:79], v[78:79], v[94:95]
    v_cvt_pk_bf16_f32 v24, v72, v73
    v_cvt_pk_bf16_f32 v25, v74, v75
    v_cvt_pk_bf16_f32 v26, v76, v77
    v_cvt_pk_bf16_f32 v27, v78, v79
    v_lshlrev_b32 v72, 16, v24
    v_and_b32 v73, 0xffff0000, v24
    v_lshlrev_b32 v74, 16, v25
    v_and_b32 v75, 0xffff0000, v25
    v_lshlrev_b32 v76, 16, v26
    v_and_b32 v77, 0xffff0000, v26
    v_lshlrev_b32 v78, 16, v27
    v_and_b32 v79, 0xffff0000, v27
    v_pk_add_f32 v[72:73], v[72:73], v[52:53]
    v_pk_add_f32 v[74:75], v[74:75], v[54:55]
    v_pk_add_f32 v[76:77], v[76:77], v[56:57]
    v_pk_add_f32 v[78:79], v[78:79], v[58:59]
    v_cvt_pk_bf16_f32 v24, v72, v73
    v_cvt_pk_bf16_f32 v25, v74, v75
    v_cvt_pk_bf16_f32 v26, v76, v77
    v_cvt_pk_bf16_f32 v27, v78, v79
    v_lshlrev_b32 v72, 16, v24
    v_and_b32 v73, 0xffff0000, v24
    v_lshlrev_b32 v74, 16, v25
    v_and_b32 v75, 0xffff0000, v25
    v_lshlrev_b32 v76, 16, v26
    v_and_b32 v77, 0xffff0000, v26
    v_lshlrev_b32 v78, 16, v27
    v_and_b32 v79, 0xffff0000, v27
    v_pk_add_f32 v[72:73], v[72:73], v[104:105]
    v_pk_add_f32 v[74:75], v[74:75], v[106:107]
    v_pk_add_f32 v[76:77], v[76:77], v[108:109]
    v_pk_add_f32 v[78:79], v[78:79], v[110:111]
    v_cvt_pk_bf16_f32 v116, v72, v73
    v_cvt_pk_bf16_f32 v117, v74, v75
    v_cvt_pk_bf16_f32 v118, v76, v77
    v_cvt_pk_bf16_f32 v119, v78, v79
    s_nop 1
    v_permlane16_swap_b32 v116, v118
    v_permlane16_swap_b32 v117, v119
    buffer_store_dwordx4 v[116:119], v6, s[8:11], s35 offen offset:1024 sc1
    s_branch Lcv_fin
Lcv_ep1:
    ds_read_b64 v[8:9], v121 offset:2048
    ds_read_b64 v[10:11], v121 offset:2560
    ds_read_b64 v[12:13], v121 offset:3072
    ds_read_b64 v[14:15], v121 offset:3584
    ds_read_b64 v[16:17], v122 offset:2048
    ds_read_b64 v[18:19], v122 offset:2560
    ds_read_b64 v[20:21], v122 offset:3072
    ds_read_b64 v[22:23], v122 offset:3584
    ds_write_b128 v43, v[64:67] offset:0
    ds_write_b128 v43, v[68:71] offset:1024
    ds_write_b128 v43, v[72:75] offset:2048
    ds_write_b128 v43, v[76:79] offset:3072
    s_waitcnt lgkmcnt(8)
    v_lshlrev_b32 v44, 16, v8
    v_and_b32 v45, 0xffff0000, v8
    v_pk_mul_f32 v[44:45], v[44:45], s[30:31]
    v_cvt_pk_bf16_f32 v8, v44, v45
    v_lshlrev_b32 v46, 16, v9
    v_and_b32 v47, 0xffff0000, v9
    v_pk_mul_f32 v[46:47], v[46:47], s[30:31]
    v_cvt_pk_bf16_f32 v9, v46, v47
    v_lshlrev_b32 v48, 16, v10
    v_and_b32 v49, 0xffff0000, v10
    v_pk_mul_f32 v[48:49], v[48:49], s[30:31]
    v_cvt_pk_bf16_f32 v10, v48, v49
    v_lshlrev_b32 v50, 16, v11
    v_and_b32 v51, 0xffff0000, v11
    v_pk_mul_f32 v[50:51], v[50:51], s[30:31]
    v_cvt_pk_bf16_f32 v11, v50, v51
    v_lshlrev_b32 v52, 16, v12
    v_and_b32 v53, 0xffff0000, v12
    v_pk_mul_f32 v[52:53], v[52:53], s[30:31]
    v_cvt_pk_bf16_f32 v12, v52, v53
    v_lshlrev_b32 v54, 16, v13
    v_and_b32 v55, 0xffff0000, v13
    v_pk_mul_f32 v[54:55], v[54:55], s[30:31]
    v_cvt_pk_bf16_f32 v13, v54, v55
    v_lshlrev_b32 v56, 16, v14
    v_and_b32 v57, 0xffff0000, v14
    v_pk_mul_f32 v[56:57], v[56:57], s[30:31]
    v_cvt_pk_bf16_f32 v14, v56, v57
    v_lshlrev_b32 v58, 16, v15
    v_and_b32 v59, 0xffff0000, v15
    v_pk_mul_f32 v[58:59], v[58:59], s[30:31]
    v_cvt_pk_bf16_f32 v15, v58, v59
    s_waitcnt lgkmcnt(0)
    s_barrier
    ds_read_b128 v[64:67], v120 offset:0
    ds_read_b128 v[68:71], v120 offset:1024
    ds_read_b128 v[72:75], v120 offset:2048
    ds_read_b128 v[76:79], v120 offset:3072
    v_lshlrev_b32 v44, 16, v8
    v_and_b32 v45, 0xffff0000, v8
    v_lshlrev_b32 v96, 16, v16
    v_and_b32 v97, 0xffff0000, v16
    v_lshlrev_b32 v46, 16, v9
    v_and_b32 v47, 0xffff0000, v9
    v_lshlrev_b32 v98, 16, v17
    v_and_b32 v99, 0xffff0000, v17
    v_lshlrev_b32 v48, 16, v10
    v_and_b32 v49, 0xffff0000, v10
    v_lshlrev_b32 v100, 16, v18
    v_and_b32 v101, 0xffff0000, v18
    v_lshlrev_b32 v50, 16, v11
    v_and_b32 v51, 0xffff0000, v11
    v_lshlrev_b32 v102, 16, v19
    v_and_b32 v103, 0xffff0000, v19
    v_lshlrev_b32 v52, 16, v12
    v_and_b32 v53, 0xffff0000, v12
    v_lshlrev_b32 v104, 16, v20
    v_and_b32 v105, 0xffff0000, v20
    v_lshlrev_b32 v54, 16, v13
    v_and_b32 v55, 0xffff0000, v13
    v_lshlrev_b32 v106, 16, v21
    v_and_b32 v107, 0xffff0000, v21
    v_lshlrev_b32 v56, 16, v14
    v_and_b32 v57, 0xffff0000, v14
    v_lshlrev_b32 v108, 16, v22
    v_and_b32 v109, 0xffff0000, v22
    v_lshlrev_b32 v58, 16, v15
    v_and_b32 v59, 0xffff0000, v15
    v_lshlrev_b32 v110, 16, v23
    v_and_b32 v111, 0xffff0000, v23
    s_waitcnt lgkmcnt(2)
    v_pk_add_f32 v[80:81], v[80:81], v[64:65]
    v_pk_add_f32 v[82:83], v[82:83], v[66:67]
    v_pk_add_f32 v[84:85], v[84:85], v[68:69]
    v_pk_add_f32 v[86:87], v[86:87], v[70:71]
    v_cvt_pk_bf16_f32 v24, v80, v81
    v_cvt_pk_bf16_f32 v25, v82, v83
    v_cvt_pk_bf16_f32 v26, v84, v85
    v_cvt_pk_bf16_f32 v27, v86, v87
    v_lshlrev_b32 v80, 16, v24
    v_and_b32 v81, 0xffff0000, v24
    v_lshlrev_b32 v82, 16, v25
    v_and_b32 v83, 0xffff0000, v25
    v_lshlrev_b32 v84, 16, v26
    v_and_b32 v85, 0xffff0000, v26
    v_lshlrev_b32 v86, 16, v27
    v_and_b32 v87, 0xffff0000, v27
    v_pk_add_f32 v[80:81], v[80:81], v[44:45]
    v_pk_add_f32 v[82:83], v[82:83], v[46:47]
    v_pk_add_f32 v[84:85], v[84:85], v[48:49]
    v_pk_add_f32 v[86:87], v[86:87], v[50:51]
    v_cvt_pk_bf16_f32 v24, v80, v81
    v_cvt_pk_bf16_f32 v25, v82, v83
    v_cvt_pk_bf16_f32 v26, v84, v85
    v_cvt_pk_bf16_f32 v27, v86, v87
    v_lshlrev_b32 v80, 16, v24
    v_and_b32 v81, 0xffff0000, v24
    v_lshlrev_b32 v82, 16, v25
    v_and_b32 v83, 0xffff0000, v25
    v_lshlrev_b32 v84, 16, v26
    v_and_b32 v85, 0xffff0000, v26
    v_lshlrev_b32 v86, 16, v27
    v_and_b32 v87, 0xffff0000, v27
    v_pk_add_f32 v[80:81], v[80:81], v[96:97]
    v_pk_add_f32 v[82:83], v[82:83], v[98:99]
    v_pk_add_f32 v[84:85], v[84:85], v[100:101]
    v_pk_add_f32 v[86:87], v[86:87], v[102:103]
    v_cvt_pk_bf16_f32 v112, v80, v81
    v_cvt_pk_bf16_f32 v113, v82, v83
    v_cvt_pk_bf16_f32 v114, v84, v85
    v_cvt_pk_bf16_f32 v115, v86, v87
    s_nop 1
    v_permlane16_swap_b32 v112, v114
    v_permlane16_swap_b32 v113, v115
    buffer_store_dwordx4 v[112:115], v6, s[8:11], s35 offen offset:2048 sc1
    s_waitcnt lgkmcnt(0)
    v_pk_add_f32 v[88:89], v[88:89], v[72:73]
    v_pk_add_f32 v[90:91], v[90:91], v[74:75]
    v_pk_add_f32 v[92:93], v[92:93], v[76:77]
    v_pk_add_f32 v[94:95], v[94:95], v[78:79]
    v_cvt_pk_bf16_f32 v24, v88, v89
    v_cvt_pk_bf16_f32 v25, v90, v91
    v_cvt_pk_bf16_f32 v26, v92, v93
    v_cvt_pk_bf16_f32 v27, v94, v95
    v_lshlrev_b32 v88, 16, v24
    v_and_b32 v89, 0xffff0000, v24
    v_lshlrev_b32 v90, 16, v25
    v_and_b32 v91, 0xffff0000, v25
    v_lshlrev_b32 v92, 16, v26
    v_and_b32 v93, 0xffff0000, v26
    v_lshlrev_b32 v94, 16, v27
    v_and_b32 v95, 0xffff0000, v27
    v_pk_add_f32 v[88:89], v[88:89], v[52:53]
    v_pk_add_f32 v[90:91], v[90:91], v[54:55]
    v_pk_add_f32 v[92:93], v[92:93], v[56:57]
    v_pk_add_f32 v[94:95], v[94:95], v[58:59]
    v_cvt_pk_bf16_f32 v24, v88, v89
    v_cvt_pk_bf16_f32 v25, v90, v91
    v_cvt_pk_bf16_f32 v26, v92, v93
    v_cvt_pk_bf16_f32 v27, v94, v95
    v_lshlrev_b32 v88, 16, v24
    v_and_b32 v89, 0xffff0000, v24
    v_lshlrev_b32 v90, 16, v25
    v_and_b32 v91, 0xffff0000, v25
    v_lshlrev_b32 v92, 16, v26
    v_and_b32 v93, 0xffff0000, v26
    v_lshlrev_b32 v94, 16, v27
    v_and_b32 v95, 0xffff0000, v27
    v_pk_add_f32 v[88:89], v[88:89], v[104:105]
    v_pk_add_f32 v[90:91], v[90:91], v[106:107]
    v_pk_add_f32 v[92:93], v[92:93], v[108:109]
    v_pk_add_f32 v[94:95], v[94:95], v[110:111]
    v_cvt_pk_bf16_f32 v116, v88, v89
    v_cvt_pk_bf16_f32 v117, v90, v91
    v_cvt_pk_bf16_f32 v118, v92, v93
    v_cvt_pk_bf16_f32 v119, v94, v95
    s_nop 1
    v_permlane16_swap_b32 v116, v118
    v_permlane16_swap_b32 v117, v119
    buffer_store_dwordx4 v[116:119], v6, s[8:11], s35 offen offset:3072 sc1
Lcv_fin:
    s_waitcnt vmcnt(0)
    s_barrier
    s_cmp_lg_u32 s36, 4
    s_cbranch_scc1 Lcv_arrd
    s_lshr_b32 s12, s2, 4
    s_lshl_b32 s12, s12, 7
    s_add_u32 s12, s12, s52
    s_add_u32 s12, s12, 49152
    v_mov_b32 v12, 0
    v_mov_b32 v13, 1
    v_lshlrev_b32 v14, 7, v1
    v_mov_b32 v15, 1
    s_mov_b64 exec, 1
    buffer_atomic_add v13, v12, s[8:11], s12 offen sc0 sc1
    s_waitcnt vmcnt(0)
    v_readfirstlane_b32 s13, v13
    s_cmp_lg_u32 s13, 15
    s_cbranch_scc1 Lcv_arr1
    s_add_u32 s12, s52, 51200
    v_mov_b32 v13, 1
    buffer_atomic_add v13, v12, s[8:11], s12 offen sc0 sc1
    s_waitcnt vmcnt(0)
    v_readfirstlane_b32 s13, v13
    s_cmp_lg_u32 s13, 15
    s_cbranch_scc1 Lcv_arr1
    s_add_u32 s12, s52, 51328
    s_mov_b64 exec, 0xff
    buffer_store_dword v15, v14, s[8:11], s12 offen sc1
Lcv_arr1:
    s_mov_b64 exec, -1
Lcv_arrd:
    s_barrier
    v_lshlrev_b32 v3, 4, v1
    s_mov_b32 s46, s62
    s_and_b32 s12, s2, 7
    s_lshr_b32 s13, s2, 3
    s_lshl_b32 s54, s12, 2
    s_and_b32 s55, s13, 3
    s_add_u32 s54, s54, s55
    s_lshr_b32 s55, s13, 2
    s_bfe_u32 s56, s36, 0x10001
    s_and_b32 s57, s36, 1
    s_lshl_b32 s76, s55, 1
    s_add_u32 s76, s76, s56
    s_lshl_b32 s77, s54, 1
    s_add_u32 s77, s77, s57
    s_mul_i32 s78, s36, 14336
    s_mul_i32 s79, s55, 7
    s_lshr_b32 s79, s79, 2
    s_lshl_b32 s79, s79, 10
    s_mul_i32 s80, s76, 114688
    s_add_u32 s80, s80, s78
    s_add_u32 s80, s80, 27262976
    s_xor_b32 s81, s76, 1
    s_mul_i32 s81, s81, 114688
    s_add_u32 s81, s81, s78
    s_add_u32 s81, s81, 27262976
    s_lshr_b32 s82, s36, 2
    s_lshl_b32 s83, s82, 4
    v_xor_b32 v31, s83, v1
    v_lshlrev_b32 v31, 4, v31
    v_lshrrev_b32 v5, 5, v1
    v_bfe_u32 v10, v1, 4, 1
    s_mov_b32 s28, 0x3b000000
    s_mov_b32 s29, 0x3727c5ac
    s_cmp_ge_u32 s2, 224
    s_cbranch_scc1 Lcm_idle_h
    s_and_b32 s12, s2, 7
    s_lshr_b32 s13, s2, 3
    s_lshr_b32 s14, s12, 1
    s_lshl_b32 s14, s14, 2
    s_and_b32 s15, s13, 3
    s_add_u32 s14, s14, s15
    s_and_b32 s15, s12, 1
    s_mul_i32 s15, s15, 7
    s_lshr_b32 s16, s13, 2
    s_add_u32 s15, s15, s16
    s_mov_b32 s39, s16
    s_and_b32 s3, s36, 3
    s_lshl_b32 s16, s15, 2
    s_add_u32 s16, s16, s3
    v_lshrrev_b32 v5, 5, v1
    v_lshlrev_b32 v6, 3, v5
    v_lshlrev_b32 v7, 4, v5
    s_lshl_b32 s26, s16, 6
    s_lshl_b32 s27, s16, 7
    s_add_u32 s27, s27, 33685504
    v_bfe_u32 v10, v1, 4, 1
    s_lshl_b32 s37, s3, 12
    v_add_u32 v24, s37, v3
    v_and_b32 v25, 31, v1
    v_lshlrev_b32 v25, 3, v25
    s_lshl_b32 s47, s14, 10
    s_add_u32 s46, s46, s47
    s_lshl_b32 s47, s3, 2
    s_add_u32 s47, s47, 131072
    v_mov_b32 v29, s47
    v_mov_b32 v28, 0
    ds_write_b32 v29, v28
    s_mul_i32 s34, s14, 458752
    s_lshl_b32 s35, s16, 11
    s_add_u32 s34, s34, s35
    s_add_u32 s34, s34, s33
    s_mov_b32 s28, 0x3b000000
    s_mov_b32 s29, 0x3727c5ac
    s_mov_b32 s30, 0xbdd2d3e8
    s_mov_b32 s31, 0xbdd2d3e8
    v_mov_b32 v26, 0xc0135761
    v_mov_b32 v27, 0xc0135761
    s_waitcnt lgkmcnt(0)
    s_mov_b32 s8, s4
    s_mov_b32 s9, s5
    s_mov_b32 s10, 0x10000000
    s_mov_b32 s11, 0x00020000
    s_mov_b32 s20, s6
    s_mov_b32 s21, s7
    s_mov_b32 s22, 0xe00
    s_mov_b32 s23, 0x00020000
    s_mov_b32 s84, s79
    s_add_u32 s85, s80, s84
    s_add_u32 s86, s81, s84
    buffer_load_dwordx4 a[0:3], v31, s[8:11], s85 offen
    buffer_load_dwordx4 a[4:7], v31, s[8:11], s86 offen
    s_add_u32 s84, s84, 1024
    s_cmp_eq_u32 s84, 14336
    s_cselect_b32 s84, 0, s84
    s_add_u32 s85, s80, s84
    s_add_u32 s86, s81, s84
    buffer_load_dwordx4 a[8:11], v31, s[8:11], s85 offen
    buffer_load_dwordx4 a[12:15], v31, s[8:11], s86 offen
    s_add_u32 s84, s84, 1024
    s_cmp_eq_u32 s84, 14336
    s_cselect_b32 s84, 0, s84
    s_add_u32 s85, s80, s84
    s_add_u32 s86, s81, s84
    buffer_load_dwordx4 a[16:19], v31, s[8:11], s85 offen
    buffer_load_dwordx4 a[20:23], v31, s[8:11], s86 offen
    s_add_u32 s84, s84, 1024
    s_cmp_eq_u32 s84, 14336
    s_cselect_b32 s84, 0, s84
    s_add_u32 s85, s80, s84
    s_add_u32 s86, s81, s84
    buffer_load_dwordx4 a[24:27], v31, s[8:11], s85 offen
    buffer_load_dwordx4 a[28:31], v31, s[8:11], s86 offen
    s_add_u32 s84, s84, 1024
    s_cmp_eq_u32 s84, 14336
    s_cselect_b32 s84, 0, s84
    s_add_u32 s85, s80, s84
    s_add_u32 s86, s81, s84
    buffer_load_dwordx4 a[32:35], v31, s[8:11], s85 offen
    buffer_load_dwordx4 a[36:39], v31, s[8:11], s86 offen
    s_add_u32 s84, s84, 1024
    s_cmp_eq_u32 s84, 14336
    s_cselect_b32 s84, 0, s84
    s_add_u32 s85, s80, s84
    s_add_u32 s86, s81, s84
    buffer_load_dwordx4 a[40:43], v31, s[8:11], s85 offen
    buffer_load_dwordx4 a[44:47], v31, s[8:11], s86 offen
    s_add_u32 s84, s84, 1024
    s_cmp_eq_u32 s84, 14336
    s_cselect_b32 s84, 0, s84
    s_add_u32 s85, s80, s84
    s_add_u32 s86, s81, s84
    buffer_load_dwordx4 a[48:51], v31, s[8:11], s85 offen
    buffer_load_dwordx4 a[52:55], v31, s[8:11], s86 offen
    s_add_u32 s84, s84, 1024
    s_cmp_eq_u32 s84, 14336
    s_cselect_b32 s84, 0, s84
    s_add_u32 s85, s80, s84
    s_add_u32 s86, s81, s84
    buffer_load_dwordx4 a[56:59], v31, s[8:11], s85 offen
    buffer_load_dwordx4 a[60:63], v31, s[8:11], s86 offen
    s_add_u32 s84, s84, 1024
    s_cmp_eq_u32 s84, 14336
    s_cselect_b32 s84, 0, s84
    s_add_u32 s85, s80, s84
    s_add_u32 s86, s81, s84
    buffer_load_dwordx4 a[64:67], v31, s[8:11], s85 offen
    buffer_load_dwordx4 a[68:71], v31, s[8:11], s86 offen
    s_add_u32 s84, s84, 1024
    s_cmp_eq_u32 s84, 14336
    s_cselect_b32 s84, 0, s84
    s_add_u32 s85, s80, s84
    s_add_u32 s86, s81, s84
    buffer_load_dwordx4 a[72:75], v31, s[8:11], s85 offen
    buffer_load_dwordx4 a[76:79], v31, s[8:11], s86 offen
    s_add_u32 s84, s84, 1024
    s_cmp_eq_u32 s84, 14336
    s_cselect_b32 s84, 0, s84
    s_add_u32 s85, s80, s84
    s_add_u32 s86, s81, s84
    buffer_load_dwordx4 a[80:83], v31, s[8:11], s85 offen
    buffer_load_dwordx4 a[84:87], v31, s[8:11], s86 offen
    s_add_u32 s84, s84, 1024
    s_cmp_eq_u32 s84, 14336
    s_cselect_b32 s84, 0, s84
    s_add_u32 s85, s80, s84
    s_add_u32 s86, s81, s84
    buffer_load_dwordx4 a[88:91], v31, s[8:11], s85 offen
    buffer_load_dwordx4 a[92:95], v31, s[8:11], s86 offen
    s_add_u32 s84, s84, 1024
    s_cmp_eq_u32 s84, 14336
    s_cselect_b32 s84, 0, s84
    s_add_u32 s85, s80, s84
    s_add_u32 s86, s81, s84
    buffer_load_dwordx4 a[96:99], v31, s[8:11], s85 offen
    buffer_load_dwordx4 a[100:103], v31, s[8:11], s86 offen
    s_add_u32 s84, s84, 1024
    s_cmp_eq_u32 s84, 14336
    s_cselect_b32 s84, 0, s84
    s_add_u32 s85, s80, s84
    s_add_u32 s86, s81, s84
    buffer_load_dwordx4 a[104:107], v31, s[8:11], s85 offen
    buffer_load_dwordx4 a[108:111], v31, s[8:11], s86 offen
    s_add_u32 s84, s84, 1024
    s_cmp_eq_u32 s84, 14336
    s_cselect_b32 s84, 0, s84
    s_cmp_lg_u32 s36, 4
    s_cbranch_scc1 Lcm_go1_b
    s_and_b32 s44, s2, 7
    s_lshl_b32 s44, s44, 7
    s_add_u32 s44, s44, s52
    s_add_u32 s44, s44, 51328
    v_mov_b32 v12, 0
    s_mov_b32 s45, 0
    s_mov_b64 exec, 1
Lcm_go1:
    buffer_load_dword v13, v12, s[8:11], s44 offen sc1
    s_waitcnt vmcnt(0)
    v_readfirstlane_b32 s47, v13
    s_cmp_lg_u32 s47, 0
    s_cbranch_scc1 Lcm_go1_ok
    s_sleep 3
    s_add_u32 s45, s45, 1
    s_cmp_lt_u32 s45, 40000
    s_cbranch_scc1 Lcm_go1
Lcm_go1_ok:
    s_mov_b64 exec, -1
Lcm_go1_b:
    s_barrier
    v_lshrrev_b32 v4, 3, v1
    v_and_b32 v8, 7, v1
    v_lshlrev_b32 v10, 2, v10
    v_xor_b32 v8, v8, v10
    v_mul_u32_u24 v4, 4224, v4
    v_lshl_add_u32 v4, v8, 4, v4
    s_lshl_b32 s18, s14, 8
    s_add_u32 s18, s18, s32
    s_mul_i32 s19, s3, 33792
    s_add_u32 s18, s18, s19
    s_lshl_b32 s19, s3, 10
    s_add_u32 s45, s39, 0
    s_and_b32 s45, s45, 7
    s_mul_i32 s45, s45, 270336
    s_add_u32 s45, s45, s18
    s_add_u32 m0, s19, 0
    s_add_u32 s24, s45, 0
    buffer_load_dwordx4 v4, s[8:11], s24 offen sc1 lds
    s_add_u32 m0, s19, 4096
    s_add_u32 s24, s45, 135168
    buffer_load_dwordx4 v4, s[8:11], s24 offen sc1 lds
    s_add_u32 s45, s39, 1
    s_and_b32 s45, s45, 7
    s_mul_i32 s45, s45, 270336
    s_add_u32 s45, s45, s18
    s_add_u32 m0, s19, 8192
    s_add_u32 s24, s45, 0
    buffer_load_dwordx4 v4, s[8:11], s24 offen sc1 lds
    s_add_u32 m0, s19, 12288
    s_add_u32 s24, s45, 135168
    buffer_load_dwordx4 v4, s[8:11], s24 offen sc1 lds
    s_add_u32 s45, s39, 2
    s_and_b32 s45, s45, 7
    s_mul_i32 s45, s45, 270336
    s_add_u32 s45, s45, s18
    s_add_u32 m0, s19, 16384
    s_add_u32 s24, s45, 0
    buffer_load_dwordx4 v4, s[8:11], s24 offen sc1 lds
    s_add_u32 m0, s19, 20480
    s_add_u32 s24, s45, 135168
    buffer_load_dwordx4 v4, s[8:11], s24 offen sc1 lds
    s_add_u32 s45, s39, 3
    s_and_b32 s45, s45, 7
    s_mul_i32 s45, s45, 270336
    s_add_u32 s45, s45, s18
    s_add_u32 m0, s19, 24576
    s_add_u32 s24, s45, 0
    buffer_load_dwordx4 v4, s[8:11], s24 offen sc1 lds
    s_add_u32 m0, s19, 28672
    s_add_u32 s24, s45, 135168
    buffer_load_dwordx4 v4, s[8:11], s24 offen sc1 lds
    s_add_u32 s45, s39, 4
    s_and_b32 s45, s45, 7
    s_mul_i32 s45, s45, 270336
    s_add_u32 s45, s45, s18
    s_add_u32 m0, s19, 32768
    s_add_u32 s24, s45, 0
    buffer_load_dwordx4 v4, s[8:11], s24 offen sc1 lds
    s_add_u32 m0, s19, 36864
    s_add_u32 s24, s45, 135168
    buffer_load_dwordx4 v4, s[8:11], s24 offen sc1 lds
    s_waitcnt vmcnt(8)
    s_barrier
    s_add_u32 s45, s39, 5
    s_and_b32 s45, s45, 7
    s_mul_i32 s45, s45, 270336
    s_add_u32 s45, s45, s18
    s_add_u32 m0, s19, 40960
    s_add_u32 s24, s45, 0
    buffer_load_dwordx4 v4, s[8:11], s24 offen sc1 lds
    s_add_u32 m0, s19, 45056
    s_add_u32 s24, s45, 135168
    buffer_load_dwordx4 v4, s[8:11], s24 offen sc1 lds
    s_waitcnt vmcnt(8)
    s_barrier
    s_add_u32 s45, s39, 6
    s_and_b32 s45, s45, 7
    s_mul_i32 s45, s45, 270336
    s_add_u32 s45, s45, s18
    s_add_u32 m0, s19, 49152
    s_add_u32 s24, s45, 0
    buffer_load_dwordx4 v4, s[8:11], s24 offen sc1 lds
    s_add_u32 m0, s19, 53248
    s_add_u32 s24, s45, 135168
    buffer_load_dwordx4 v4, s[8:11], s24 offen sc1 lds
    s_waitcnt vmcnt(8)
    s_barrier
    s_add_u32 s45, s39, 7
    s_and_b32 s45, s45, 7
    s_mul_i32 s45, s45, 270336
    s_add_u32 s45, s45, s18
    s_add_u32 m0, s19, 57344
    s_add_u32 s24, s45, 0
    buffer_load_dwordx4 v4, s[8:11], s24 offen sc1 lds
    s_add_u32 m0, s19, 61440
    s_add_u32 s24, s45, 135168
    buffer_load_dwordx4 v4, s[8:11], s24 offen sc1 lds
    s_waitcnt vmcnt(8)
    s_barrier
    s_add_u32 s45, s39, 0
    s_and_b32 s45, s45, 7
    s_mul_i32 s45, s45, 270336
    s_add_u32 s45, s45, s18
    s_add_u32 m0, s19, 65536
    s_add_u32 s24, s45, 128
    buffer_load_dwordx4 v4, s[8:11], s24 offen sc1 lds
    s_add_u32 m0, s19, 69632
    s_add_u32 s24, s45, 135296
    buffer_load_dwordx4 v4, s[8:11], s24 offen sc1 lds
    s_waitcnt vmcnt(8)
    s_barrier
    s_add_u32 s45, s39, 1
    s_and_b32 s45, s45, 7
    s_mul_i32 s45, s45, 270336
    s_add_u32 s45, s45, s18
    s_add_u32 m0, s19, 73728
    s_add_u32 s24, s45, 128
    buffer_load_dwordx4 v4, s[8:11], s24 offen sc1 lds
    s_add_u32 m0, s19, 77824
    s_add_u32 s24, s45, 135296
    buffer_load_dwordx4 v4, s[8:11], s24 offen sc1 lds
    s_waitcnt vmcnt(8)
    s_barrier
    s_add_u32 s45, s39, 2
    s_and_b32 s45, s45, 7
    s_mul_i32 s45, s45, 270336
    s_add_u32 s45, s45, s18
    s_add_u32 m0, s19, 81920
    s_add_u32 s24, s45, 128
    buffer_load_dwordx4 v4, s[8:11], s24 offen sc1 lds
    s_add_u32 m0, s19, 86016
    s_add_u32 s24, s45, 135296
    buffer_load_dwordx4 v4, s[8:11], s24 offen sc1 lds
    s_add_u32 s45, s39, 3
    s_and_b32 s45, s45, 7
    s_mul_i32 s45, s45, 270336
    s_add_u32 s45, s45, s18
    s_add_u32 m0, s19, 90112
    s_add_u32 s24, s45, 128
    buffer_load_dwordx4 v4, s[8:11], s24 offen sc1 lds
    s_add_u32 m0, s19, 94208
    s_add_u32 s24, s45, 135296
    buffer_load_dwordx4 v4, s[8:11], s24 offen sc1 lds
    s_waitcnt vmcnt(10)
    s_barrier
    s_add_u32 s45, s39, 4
    s_and_b32 s45, s45, 7
    s_mul_i32 s45, s45, 270336
    s_add_u32 s45, s45, s18
    s_add_u32 m0, s19, 98304
    s_add_u32 s24, s45, 128
    buffer_load_dwordx4 v4, s[8:11], s24 offen sc1 lds
    s_add_u32 m0, s19, 102400
    s_add_u32 s24, s45, 135296
    buffer_load_dwordx4 v4, s[8:11], s24 offen sc1 lds
    s_add_u32 s45, s39, 5
    s_and_b32 s45, s45, 7
    s_mul_i32 s45, s45, 270336
    s_add_u32 s45, s45, s18
    s_add_u32 m0, s19, 106496
    s_add_u32 s24, s45, 128
    buffer_load_dwordx4 v4, s[8:11], s24 offen sc1 lds
    s_add_u32 m0, s19, 110592
    s_add_u32 s24, s45, 135296
    buffer_load_dwordx4 v4, s[8:11], s24 offen sc1 lds
    s_waitcnt vmcnt(12)
    s_barrier
    buffer_load_dwordx2 v[12:13], v25, s[8:11], s46 offen offset:0 sc1
    buffer_load_dwordx2 v[14:15], v25, s[8:11], s46 offen offset:256 sc1
    buffer_load_dwordx2 v[16:17], v25, s[8:11], s46 offen offset:512 sc1
    buffer_load_dwordx2 v[18:19], v25, s[8:11], s46 offen offset:768 sc1
    s_add_u32 s45, s39, 6
    s_and_b32 s45, s45, 7
    s_mul_i32 s45, s45, 270336
    s_add_u32 s45, s45, s18
    s_add_u32 m0, s19, 114688
    s_add_u32 s24, s45, 128
    buffer_load_dwordx4 v4, s[8:11], s24 offen sc1 lds
    s_add_u32 m0, s19, 118784
    s_add_u32 s24, s45, 135296
    buffer_load_dwordx4 v4, s[8:11], s24 offen sc1 lds
    s_add_u32 s45, s39, 7
    s_and_b32 s45, s45, 7
    s_mul_i32 s45, s45, 270336
    s_add_u32 s45, s45, s18
    s_add_u32 m0, s19, 122880
    s_add_u32 s24, s45, 128
    buffer_load_dwordx4 v4, s[8:11], s24 offen sc1 lds
    s_add_u32 m0, s19, 126976
    s_add_u32 s24, s45, 135296
    buffer_load_dwordx4 v4, s[8:11], s24 offen sc1 lds
    buffer_load_dwordx2 v[96:97], v6, s[20:23], s26 offen offset:0
    buffer_load_dwordx2 v[98:99], v6, s[20:23], s26 offen offset:16
    buffer_load_dwordx2 v[100:101], v6, s[20:23], s26 offen offset:32
    buffer_load_dwordx2 v[102:103], v6, s[20:23], s26 offen offset:48
    buffer_load_dwordx4 v[80:83], v7, s[8:11], s27 offen offset:0
    buffer_load_dwordx4 v[84:87], v7, s[8:11], s27 offen offset:32
    buffer_load_dwordx4 v[88:91], v7, s[8:11], s27 offen offset:64
    buffer_load_dwordx4 v[92:95], v7, s[8:11], s27 offen offset:96
    s_waitcnt vmcnt(22)
    s_barrier
    v_add_u32 v30, 131072, v25
    s_barrier
    s_waitcnt vmcnt(0)
    v_lshlrev_b32 v64, 16, v96
    v_and_b32 v65, 0xffff0000, v96
    v_lshlrev_b32 v66, 16, v97
    v_and_b32 v67, 0xffff0000, v97
    v_lshlrev_b32 v68, 16, v98
    v_and_b32 v69, 0xffff0000, v98
    v_lshlrev_b32 v70, 16, v99
    v_and_b32 v71, 0xffff0000, v99
    v_lshlrev_b32 v72, 16, v100
    v_and_b32 v73, 0xffff0000, v100
    v_lshlrev_b32 v74, 16, v101
    v_and_b32 v75, 0xffff0000, v101
    v_lshlrev_b32 v76, 16, v102
    v_and_b32 v77, 0xffff0000, v102
    v_lshlrev_b32 v78, 16, v103
    v_and_b32 v79, 0xffff0000, v103
    s_barrier
    s_mov_b32 s44, 0
Lg1_sp:
    v_min_u32 v20, v12, v14
    v_min_u32 v21, v16, v18
    v_min_u32 v20, v20, v21
    v_cmp_eq_u32 vcc, 0, v20
    s_cmp_eq_u64 vcc, 0
    s_cbranch_scc1 Lg1_spok
    s_sleep 4
    buffer_load_dwordx2 v[12:13], v25, s[8:11], s46 offen offset:0 sc1
    buffer_load_dwordx2 v[14:15], v25, s[8:11], s46 offen offset:256 sc1
    buffer_load_dwordx2 v[16:17], v25, s[8:11], s46 offen offset:512 sc1
    buffer_load_dwordx2 v[18:19], v25, s[8:11], s46 offen offset:768 sc1
    s_add_u32 s44, s44, 1
    s_waitcnt vmcnt(0)
    s_cmp_lt_u32 s44, 40000
    s_cbranch_scc1 Lg1_sp
Lg1_spok:
    ds_read_b128 v[40:43], v24 offset:0
    ds_read_b128 v[44:47], v24 offset:1024
    ds_read_b128 v[48:51], v24 offset:2048
    ds_read_b128 v[52:55], v24 offset:3072
    ds_read_b128 v[104:107], v24 offset:16384
    ds_read_b128 v[108:111], v24 offset:17408
    ds_read_b128 v[112:115], v24 offset:18432
    ds_read_b128 v[116:119], v24 offset:19456
    s_waitcnt lgkmcnt(4)
    v_fma_f32 v36, -v13, v80, v64
    v_fma_f32 v37, -v13, v81, v65
    v_fma_f32 v38, -v13, v82, v66
    v_fma_f32 v39, -v13, v83, v67
    v_fma_f32 v40, v40, v12, v36
    v_fma_f32 v41, v41, v12, v37
    v_fma_f32 v42, v42, v12, v38
    v_fma_f32 v43, v43, v12, v39
    v_mul_f32 v32, v40, v40
    v_mul_f32 v33, v41, v41
    v_mul_f32 v34, v42, v42
    v_mul_f32 v35, v43, v43
    v_fma_f32 v32, v32, s31, v26
    v_fma_f32 v33, v33, s31, v26
    v_fma_f32 v34, v34, s31, v26
    v_fma_f32 v35, v35, s31, v26
    v_mul_f32 v32, v32, v40
    v_mul_f32 v33, v33, v41
    v_mul_f32 v34, v34, v42
    v_mul_f32 v35, v35, v43
    v_exp_f32 v32, v32
    v_exp_f32 v33, v33
    v_exp_f32 v34, v34
    v_exp_f32 v35, v35
    v_add_f32 v32, 1.0, v32
    v_add_f32 v33, 1.0, v33
    v_add_f32 v34, 1.0, v34
    v_add_f32 v35, 1.0, v35
    v_rcp_f32 v32, v32
    v_rcp_f32 v33, v33
    v_rcp_f32 v34, v34
    v_rcp_f32 v35, v35
    v_mul_f32 v40, v40, v32
    v_mul_f32 v41, v41, v33
    v_mul_f32 v42, v42, v34
    v_mul_f32 v43, v43, v35
    v_cvt_pk_bf16_f32 v120, v40, v41
    v_cvt_pk_bf16_f32 v121, v42, v43
    v_fma_f32 v36, -v13, v84, v68
    v_fma_f32 v37, -v13, v85, v69
    v_fma_f32 v38, -v13, v86, v70
    v_fma_f32 v39, -v13, v87, v71
    v_fma_f32 v44, v44, v12, v36
    v_fma_f32 v45, v45, v12, v37
    v_fma_f32 v46, v46, v12, v38
    v_fma_f32 v47, v47, v12, v39
    v_mul_f32 v32, v44, v44
    v_mul_f32 v33, v45, v45
    v_mul_f32 v34, v46, v46
    v_mul_f32 v35, v47, v47
    v_fma_f32 v32, v32, s31, v26
    v_fma_f32 v33, v33, s31, v26
    v_fma_f32 v34, v34, s31, v26
    v_fma_f32 v35, v35, s31, v26
    v_mul_f32 v32, v32, v44
    v_mul_f32 v33, v33, v45
    v_mul_f32 v34, v34, v46
    v_mul_f32 v35, v35, v47
    v_exp_f32 v32, v32
    v_exp_f32 v33, v33
    v_exp_f32 v34, v34
    v_exp_f32 v35, v35
    v_add_f32 v32, 1.0, v32
    v_add_f32 v33, 1.0, v33
    v_add_f32 v34, 1.0, v34
    v_add_f32 v35, 1.0, v35
    v_rcp_f32 v32, v32
    v_rcp_f32 v33, v33
    v_rcp_f32 v34, v34
    v_rcp_f32 v35, v35
    v_mul_f32 v44, v44, v32
    v_mul_f32 v45, v45, v33
    v_mul_f32 v46, v46, v34
    v_mul_f32 v47, v47, v35
    v_cvt_pk_bf16_f32 v122, v44, v45
    v_cvt_pk_bf16_f32 v123, v46, v47
    v_fma_f32 v36, -v13, v88, v72
    v_fma_f32 v37, -v13, v89, v73
    v_fma_f32 v38, -v13, v90, v74
    v_fma_f32 v39, -v13, v91, v75
    v_fma_f32 v48, v48, v12, v36
    v_fma_f32 v49, v49, v12, v37
    v_fma_f32 v50, v50, v12, v38
    v_fma_f32 v51, v51, v12, v39
    v_mul_f32 v32, v48, v48
    v_mul_f32 v33, v49, v49
    v_mul_f32 v34, v50, v50
    v_mul_f32 v35, v51, v51
    v_fma_f32 v32, v32, s31, v26
    v_fma_f32 v33, v33, s31, v26
    v_fma_f32 v34, v34, s31, v26
    v_fma_f32 v35, v35, s31, v26
    v_mul_f32 v32, v32, v48
    v_mul_f32 v33, v33, v49
    v_mul_f32 v34, v34, v50
    v_mul_f32 v35, v35, v51
    v_exp_f32 v32, v32
    v_exp_f32 v33, v33
    v_exp_f32 v34, v34
    v_exp_f32 v35, v35
    v_add_f32 v32, 1.0, v32
    v_add_f32 v33, 1.0, v33
    v_add_f32 v34, 1.0, v34
    v_add_f32 v35, 1.0, v35
    v_rcp_f32 v32, v32
    v_rcp_f32 v33, v33
    v_rcp_f32 v34, v34
    v_rcp_f32 v35, v35
    v_mul_f32 v48, v48, v32
    v_mul_f32 v49, v49, v33
    v_mul_f32 v50, v50, v34
    v_mul_f32 v51, v51, v35
    v_cvt_pk_bf16_f32 v124, v48, v49
    v_cvt_pk_bf16_f32 v125, v50, v51
    v_fma_f32 v36, -v13, v92, v76
    v_fma_f32 v37, -v13, v93, v77
    v_fma_f32 v38, -v13, v94, v78
    v_fma_f32 v39, -v13, v95, v79
    v_fma_f32 v52, v52, v12, v36
    v_fma_f32 v53, v53, v12, v37
    v_fma_f32 v54, v54, v12, v38
    v_fma_f32 v55, v55, v12, v39
    v_mul_f32 v32, v52, v52
    v_mul_f32 v33, v53, v53
    v_mul_f32 v34, v54, v54
    v_mul_f32 v35, v55, v55
    v_fma_f32 v32, v32, s31, v26
    v_fma_f32 v33, v33, s31, v26
    v_fma_f32 v34, v34, s31, v26
    v_fma_f32 v35, v35, s31, v26
    v_mul_f32 v32, v32, v52
    v_mul_f32 v33, v33, v53
    v_mul_f32 v34, v34, v54
    v_mul_f32 v35, v35, v55
    v_exp_f32 v32, v32
    v_exp_f32 v33, v33
    v_exp_f32 v34, v34
    v_exp_f32 v35, v35
    v_add_f32 v32, 1.0, v32
    v_add_f32 v33, 1.0, v33
    v_add_f32 v34, 1.0, v34
    v_add_f32 v35, 1.0, v35
    v_rcp_f32 v32, v32
    v_rcp_f32 v33, v33
    v_rcp_f32 v34, v34
    v_rcp_f32 v35, v35
    v_mul_f32 v52, v52, v32
    v_mul_f32 v53, v53, v33
    v_mul_f32 v54, v54, v34
    v_mul_f32 v55, v55, v35
    v_cvt_pk_bf16_f32 v126, v52, v53
    v_cvt_pk_bf16_f32 v127, v54, v55
    s_add_u32 s35, s34, 0
    buffer_store_dwordx4 v[120:123], v3, s[8:11], s35 offen sc1
    buffer_store_dwordx4 v[124:127], v3, s[8:11], s35 offen offset:1024 sc1
    s_waitcnt lgkmcnt(0)
    v_fma_f32 v36, -v15, v80, v64
    v_fma_f32 v37, -v15, v81, v65
    v_fma_f32 v38, -v15, v82, v66
    v_fma_f32 v39, -v15, v83, v67
    v_fma_f32 v104, v104, v14, v36
    v_fma_f32 v105, v105, v14, v37
    v_fma_f32 v106, v106, v14, v38
    v_fma_f32 v107, v107, v14, v39
    v_mul_f32 v32, v104, v104
    v_mul_f32 v33, v105, v105
    v_mul_f32 v34, v106, v106
    v_mul_f32 v35, v107, v107
    v_fma_f32 v32, v32, s31, v26
    v_fma_f32 v33, v33, s31, v26
    v_fma_f32 v34, v34, s31, v26
    v_fma_f32 v35, v35, s31, v26
    v_mul_f32 v32, v32, v104
    v_mul_f32 v33, v33, v105
    v_mul_f32 v34, v34, v106
    v_mul_f32 v35, v35, v107
    v_exp_f32 v32, v32
    v_exp_f32 v33, v33
    v_exp_f32 v34, v34
    v_exp_f32 v35, v35
    v_add_f32 v32, 1.0, v32
    v_add_f32 v33, 1.0, v33
    v_add_f32 v34, 1.0, v34
    v_add_f32 v35, 1.0, v35
    v_rcp_f32 v32, v32
    v_rcp_f32 v33, v33
    v_rcp_f32 v34, v34
    v_rcp_f32 v35, v35
    v_mul_f32 v104, v104, v32
    v_mul_f32 v105, v105, v33
    v_mul_f32 v106, v106, v34
    v_mul_f32 v107, v107, v35
    v_cvt_pk_bf16_f32 v96, v104, v105
    v_cvt_pk_bf16_f32 v97, v106, v107
    v_fma_f32 v36, -v15, v84, v68
    v_fma_f32 v37, -v15, v85, v69
    v_fma_f32 v38, -v15, v86, v70
    v_fma_f32 v39, -v15, v87, v71
    v_fma_f32 v108, v108, v14, v36
    v_fma_f32 v109, v109, v14, v37
    v_fma_f32 v110, v110, v14, v38
    v_fma_f32 v111, v111, v14, v39
    v_mul_f32 v32, v108, v108
    v_mul_f32 v33, v109, v109
    v_mul_f32 v34, v110, v110
    v_mul_f32 v35, v111, v111
    v_fma_f32 v32, v32, s31, v26
    v_fma_f32 v33, v33, s31, v26
    v_fma_f32 v34, v34, s31, v26
    v_fma_f32 v35, v35, s31, v26
    v_mul_f32 v32, v32, v108
    v_mul_f32 v33, v33, v109
    v_mul_f32 v34, v34, v110
    v_mul_f32 v35, v35, v111
    v_exp_f32 v32, v32
    v_exp_f32 v33, v33
    v_exp_f32 v34, v34
    v_exp_f32 v35, v35
    v_add_f32 v32, 1.0, v32
    v_add_f32 v33, 1.0, v33
    v_add_f32 v34, 1.0, v34
    v_add_f32 v35, 1.0, v35
    v_rcp_f32 v32, v32
    v_rcp_f32 v33, v33
    v_rcp_f32 v34, v34
    v_rcp_f32 v35, v35
    v_mul_f32 v108, v108, v32
    v_mul_f32 v109, v109, v33
    v_mul_f32 v110, v110, v34
    v_mul_f32 v111, v111, v35
    v_cvt_pk_bf16_f32 v98, v108, v109
    v_cvt_pk_bf16_f32 v99, v110, v111
    v_fma_f32 v36, -v15, v88, v72
    v_fma_f32 v37, -v15, v89, v73
    v_fma_f32 v38, -v15, v90, v74
    v_fma_f32 v39, -v15, v91, v75
    v_fma_f32 v112, v112, v14, v36
    v_fma_f32 v113, v113, v14, v37
    v_fma_f32 v114, v114, v14, v38
    v_fma_f32 v115, v115, v14, v39
    v_mul_f32 v32, v112, v112
    v_mul_f32 v33, v113, v113
    v_mul_f32 v34, v114, v114
    v_mul_f32 v35, v115, v115
    v_fma_f32 v32, v32, s31, v26
    v_fma_f32 v33, v33, s31, v26
    v_fma_f32 v34, v34, s31, v26
    v_fma_f32 v35, v35, s31, v26
    v_mul_f32 v32, v32, v112
    v_mul_f32 v33, v33, v113
    v_mul_f32 v34, v34, v114
    v_mul_f32 v35, v35, v115
    v_exp_f32 v32, v32
    v_exp_f32 v33, v33
    v_exp_f32 v34, v34
    v_exp_f32 v35, v35
    v_add_f32 v32, 1.0, v32
    v_add_f32 v33, 1.0, v33
    v_add_f32 v34, 1.0, v34
    v_add_f32 v35, 1.0, v35
    v_rcp_f32 v32, v32
    v_rcp_f32 v33, v33
    v_rcp_f32 v34, v34
    v_rcp_f32 v35, v35
    v_mul_f32 v112, v112, v32
    v_mul_f32 v113, v113, v33
    v_mul_f32 v114, v114, v34
    v_mul_f32 v115, v115, v35
    v_cvt_pk_bf16_f32 v100, v112, v113
    v_cvt_pk_bf16_f32 v101, v114, v115
    v_fma_f32 v36, -v15, v92, v76
    v_fma_f32 v37, -v15, v93, v77
    v_fma_f32 v38, -v15, v94, v78
    v_fma_f32 v39, -v15, v95, v79
    v_fma_f32 v116, v116, v14, v36
    v_fma_f32 v117, v117, v14, v37
    v_fma_f32 v118, v118, v14, v38
    v_fma_f32 v119, v119, v14, v39
    v_mul_f32 v32, v116, v116
    v_mul_f32 v33, v117, v117
    v_mul_f32 v34, v118, v118
    v_mul_f32 v35, v119, v119
    v_fma_f32 v32, v32, s31, v26
    v_fma_f32 v33, v33, s31, v26
    v_fma_f32 v34, v34, s31, v26
    v_fma_f32 v35, v35, s31, v26
    v_mul_f32 v32, v32, v116
    v_mul_f32 v33, v33, v117
    v_mul_f32 v34, v34, v118
    v_mul_f32 v35, v35, v119
    v_exp_f32 v32, v32
    v_exp_f32 v33, v33
    v_exp_f32 v34, v34
    v_exp_f32 v35, v35
    v_add_f32 v32, 1.0, v32
    v_add_f32 v33, 1.0, v33
    v_add_f32 v34, 1.0, v34
    v_add_f32 v35, 1.0, v35
    v_rcp_f32 v32, v32
    v_rcp_f32 v33, v33
    v_rcp_f32 v34, v34
    v_rcp_f32 v35, v35
    v_mul_f32 v116, v116, v32
    v_mul_f32 v117, v117, v33
    v_mul_f32 v118, v118, v34
    v_mul_f32 v119, v119, v35
    v_cvt_pk_bf16_f32 v102, v116, v117
    v_cvt_pk_bf16_f32 v103, v118, v119
    s_add_u32 s35, s34, 114688
    buffer_store_dwordx4 v[96:99], v3, s[8:11], s35 offen sc1
    buffer_store_dwordx4 v[100:103], v3, s[8:11], s35 offen offset:1024 sc1
    s_branch Lg1_fin
Lcm_idle_m:
    s_waitcnt lgkmcnt(0)
    s_mov_b32 s8, s4
    s_mov_b32 s9, s5
    s_mov_b32 s10, 0x10000000
    s_mov_b32 s11, 0x00020000
    s_barrier
    s_mov_b32 s84, s79
    s_add_u32 s85, s80, s84
    s_add_u32 s86, s81, s84
    buffer_load_dwordx4 a[0:3], v31, s[8:11], s85 offen
    buffer_load_dwordx4 a[4:7], v31, s[8:11], s86 offen
    s_add_u32 s84, s84, 1024
    s_cmp_eq_u32 s84, 14336
    s_cselect_b32 s84, 0, s84
    s_add_u32 s85, s80, s84
    s_add_u32 s86, s81, s84
    buffer_load_dwordx4 a[8:11], v31, s[8:11], s85 offen
    buffer_load_dwordx4 a[12:15], v31, s[8:11], s86 offen
    s_add_u32 s84, s84, 1024
    s_cmp_eq_u32 s84, 14336
    s_cselect_b32 s84, 0, s84
    s_add_u32 s85, s80, s84
    s_add_u32 s86, s81, s84
    buffer_load_dwordx4 a[16:19], v31, s[8:11], s85 offen
    buffer_load_dwordx4 a[20:23], v31, s[8:11], s86 offen
    s_add_u32 s84, s84, 1024
    s_cmp_eq_u32 s84, 14336
    s_cselect_b32 s84, 0, s84
    s_add_u32 s85, s80, s84
    s_add_u32 s86, s81, s84
    buffer_load_dwordx4 a[24:27], v31, s[8:11], s85 offen
    buffer_load_dwordx4 a[28:31], v31, s[8:11], s86 offen
    s_add_u32 s84, s84, 1024
    s_cmp_eq_u32 s84, 14336
    s_cselect_b32 s84, 0, s84
    s_add_u32 s85, s80, s84
    s_add_u32 s86, s81, s84
    buffer_load_dwordx4 a[32:35], v31, s[8:11], s85 offen
    buffer_load_dwordx4 a[36:39], v31, s[8:11], s86 offen
    s_add_u32 s84, s84, 1024
    s_cmp_eq_u32 s84, 14336
    s_cselect_b32 s84, 0, s84
    s_add_u32 s85, s80, s84
    s_add_u32 s86, s81, s84
    buffer_load_dwordx4 a[40:43], v31, s[8:11], s85 offen
    buffer_load_dwordx4 a[44:47], v31, s[8:11], s86 offen
    s_add_u32 s84, s84, 1024
    s_cmp_eq_u32 s84, 14336
    s_cselect_b32 s84, 0, s84
    s_add_u32 s85, s80, s84
    s_add_u32 s86, s81, s84
    buffer_load_dwordx4 a[48:51], v31, s[8:11], s85 offen
    buffer_load_dwordx4 a[52:55], v31, s[8:11], s86 offen
    s_add_u32 s84, s84, 1024
    s_cmp_eq_u32 s84, 14336
    s_cselect_b32 s84, 0, s84
    s_add_u32 s85, s80, s84
    s_add_u32 s86, s81, s84
    buffer_load_dwordx4 a[56:59], v31, s[8:11], s85 offen
    buffer_load_dwordx4 a[60:63], v31, s[8:11], s86 offen
    s_add_u32 s84, s84, 1024
    s_cmp_eq_u32 s84, 14336
    s_cselect_b32 s84, 0, s84
    s_add_u32 s85, s80, s84
    s_add_u32 s86, s81, s84
    buffer_load_dwordx4 a[64:67], v31, s[8:11], s85 offen
    buffer_load_dwordx4 a[68:71], v31, s[8:11], s86 offen
    s_add_u32 s84, s84, 1024
    s_cmp_eq_u32 s84, 14336
    s_cselect_b32 s84, 0, s84
    s_add_u32 s85, s80, s84
    s_add_u32 s86, s81, s84
    buffer_load_dwordx4 a[72:75], v31, s[8:11], s85 offen
    buffer_load_dwordx4 a[76:79], v31, s[8:11], s86 offen
    s_add_u32 s84, s84, 1024
    s_cmp_eq_u32 s84, 14336
    s_cselect_b32 s84, 0, s84
    s_add_u32 s85, s80, s84
    s_add_u32 s86, s81, s84
    buffer_load_dwordx4 a[80:83], v31, s[8:11], s85 offen
    buffer_load_dwordx4 a[84:87], v31, s[8:11], s86 offen
    s_add_u32 s84, s84, 1024
    s_cmp_eq_u32 s84, 14336
    s_cselect_b32 s84, 0, s84
    s_add_u32 s85, s80, s84
    s_add_u32 s86, s81, s84
    buffer_load_dwordx4 a[88:91], v31, s[8:11], s85 offen
    buffer_load_dwordx4 a[92:95], v31, s[8:11], s86 offen
    s_add_u32 s84, s84, 1024
    s_cmp_eq_u32 s84, 14336
    s_cselect_b32 s84, 0, s84
    s_add_u32 s85, s80, s84
    s_add_u32 s86, s81, s84
    buffer_load_dwordx4 a[96:99], v31, s[8:11], s85 offen
    buffer_load_dwordx4 a[100:103], v31, s[8:11], s86 offen
    s_add_u32 s84, s84, 1024
    s_cmp_eq_u32 s84, 14336
    s_cselect_b32 s84, 0, s84
    s_add_u32 s85, s80, s84
    s_add_u32 s86, s81, s84
    buffer_load_dwordx4 a[104:107], v31, s[8:11], s85 offen
    buffer_load_dwordx4 a[108:111], v31, s[8:11], s86 offen
    s_add_u32 s84, s84, 1024
    s_cmp_eq_u32 s84, 14336
    s_cselect_b32 s84, 0, s84
    s_barrier
    s_barrier
    s_barrier
    s_barrier
    s_branch Lcm_stats
Lcm_idle_h:
    s_mov_b32 s84, s79
    s_add_u32 s85, s80, s84
    s_add_u32 s86, s81, s84
    buffer_load_dwordx4 a[0:3], v31, s[8:11], s85 offen
    buffer_load_dwordx4 a[4:7], v31, s[8:11], s86 offen
    s_add_u32 s84, s84, 1024
    s_cmp_eq_u32 s84, 14336
    s_cselect_b32 s84, 0, s84
    s_add_u32 s85, s80, s84
    s_add_u32 s86, s81, s84
    buffer_load_dwordx4 a[8:11], v31, s[8:11], s85 offen
    buffer_load_dwordx4 a[12:15], v31, s[8:11], s86 offen
    s_add_u32 s84, s84, 1024
    s_cmp_eq_u32 s84, 14336
    s_cselect_b32 s84, 0, s84
    s_add_u32 s85, s80, s84
    s_add_u32 s86, s81, s84
    buffer_load_dwordx4 a[16:19], v31, s[8:11], s85 offen
    buffer_load_dwordx4 a[20:23], v31, s[8:11], s86 offen
    s_add_u32 s84, s84, 1024
    s_cmp_eq_u32 s84, 14336
    s_cselect_b32 s84, 0, s84
    s_add_u32 s85, s80, s84
    s_add_u32 s86, s81, s84
    buffer_load_dwordx4 a[24:27], v31, s[8:11], s85 offen
    buffer_load_dwordx4 a[28:31], v31, s[8:11], s86 offen
    s_add_u32 s84, s84, 1024
    s_cmp_eq_u32 s84, 14336
    s_cselect_b32 s84, 0, s84
    s_add_u32 s85, s80, s84
    s_add_u32 s86, s81, s84
    buffer_load_dwordx4 a[32:35], v31, s[8:11], s85 offen
    buffer_load_dwordx4 a[36:39], v31, s[8:11], s86 offen
    s_add_u32 s84, s84, 1024
    s_cmp_eq_u32 s84, 14336
    s_cselect_b32 s84, 0, s84
    s_add_u32 s85, s80, s84
    s_add_u32 s86, s81, s84
    buffer_load_dwordx4 a[40:43], v31, s[8:11], s85 offen
    buffer_load_dwordx4 a[44:47], v31, s[8:11], s86 offen
    s_add_u32 s84, s84, 1024
    s_cmp_eq_u32 s84, 14336
    s_cselect_b32 s84, 0, s84
    s_add_u32 s85, s80, s84
    s_add_u32 s86, s81, s84
    buffer_load_dwordx4 a[48:51], v31, s[8:11], s85 offen
    buffer_load_dwordx4 a[52:55], v31, s[8:11], s86 offen
    s_add_u32 s84, s84, 1024
    s_cmp_eq_u32 s84, 14336
    s_cselect_b32 s84, 0, s84
    s_add_u32 s85, s80, s84
    s_add_u32 s86, s81, s84
    buffer_load_dwordx4 a[56:59], v31, s[8:11], s85 offen
    buffer_load_dwordx4 a[60:63], v31, s[8:11], s86 offen
    s_add_u32 s84, s84, 1024
    s_cmp_eq_u32 s84, 14336
    s_cselect_b32 s84, 0, s84
    s_add_u32 s85, s80, s84
    s_add_u32 s86, s81, s84
    buffer_load_dwordx4 a[64:67], v31, s[8:11], s85 offen
    buffer_load_dwordx4 a[68:71], v31, s[8:11], s86 offen
    s_add_u32 s84, s84, 1024
    s_cmp_eq_u32 s84, 14336
    s_cselect_b32 s84, 0, s84
    s_add_u32 s85, s80, s84
    s_add_u32 s86, s81, s84
    buffer_load_dwordx4 a[72:75], v31, s[8:11], s85 offen
    buffer_load_dwordx4 a[76:79], v31, s[8:11], s86 offen
    s_add_u32 s84, s84, 1024
    s_cmp_eq_u32 s84, 14336
    s_cselect_b32 s84, 0, s84
    s_add_u32 s85, s80, s84
    s_add_u32 s86, s81, s84
    buffer_load_dwordx4 a[80:83], v31, s[8:11], s85 offen
    buffer_load_dwordx4 a[84:87], v31, s[8:11], s86 offen
    s_add_u32 s84, s84, 1024
    s_cmp_eq_u32 s84, 14336
    s_cselect_b32 s84, 0, s84
    s_add_u32 s85, s80, s84
    s_add_u32 s86, s81, s84
    buffer_load_dwordx4 a[88:91], v31, s[8:11], s85 offen
    buffer_load_dwordx4 a[92:95], v31, s[8:11], s86 offen
    s_add_u32 s84, s84, 1024
    s_cmp_eq_u32 s84, 14336
    s_cselect_b32 s84, 0, s84
    s_add_u32 s85, s80, s84
    s_add_u32 s86, s81, s84
    buffer_load_dwordx4 a[96:99], v31, s[8:11], s85 offen
    buffer_load_dwordx4 a[100:103], v31, s[8:11], s86 offen
    s_add_u32 s84, s84, 1024
    s_cmp_eq_u32 s84, 14336
    s_cselect_b32 s84, 0, s84
    s_add_u32 s85, s80, s84
    s_add_u32 s86, s81, s84
    buffer_load_dwordx4 a[104:107], v31, s[8:11], s85 offen
    buffer_load_dwordx4 a[108:111], v31, s[8:11], s86 offen
    s_add_u32 s84, s84, 1024
    s_cmp_eq_u32 s84, 14336
    s_cselect_b32 s84, 0, s84
    s_cmp_lg_u32 s36, 4
    s_cbranch_scc1 Lcm_go2_b
    s_and_b32 s44, s2, 7
    s_lshl_b32 s44, s44, 7
    s_add_u32 s44, s44, s52
    s_add_u32 s44, s44, 51328
    v_mov_b32 v12, 0
    s_mov_b32 s45, 0
    s_mov_b64 exec, 1
Lcm_go2:
    buffer_load_dword v13, v12, s[8:11], s44 offen sc1
    s_waitcnt vmcnt(0)
    v_readfirstlane_b32 s47, v13
    s_cmp_lg_u32 s47, 0
    s_cbranch_scc1 Lcm_go2_ok
    s_sleep 3
    s_add_u32 s45, s45, 1
    s_cmp_lt_u32 s45, 40000
    s_cbranch_scc1 Lcm_go2
Lcm_go2_ok:
    s_mov_b64 exec, -1
Lcm_go2_b:
    s_barrier
Lcm_stats:
    s_sub_u32 s14, s2, 224
    v_lshrrev_b32 v4, 3, v1
    v_and_b32 v8, 7, v1
    v_lshlrev_b32 v9, 2, v10
    v_xor_b32 v8, v8, v9
    v_mul_u32_u24 v4, 4224, v4
    v_lshl_add_u32 v4, v8, 4, v4
    s_lshl_b32 s18, s14, 7
    s_add_u32 s18, s18, s32
    s_mul_i32 s19, s36, 33792
    s_add_u32 s18, s18, s19
    s_lshl_b32 s19, s36, 10
    s_add_u32 m0, s19, 0
    s_add_u32 s24, s18, 0
    buffer_load_dwordx4 v4, s[8:11], s24 offen sc1 lds
    s_add_u32 m0, s19, 8192
    s_add_u32 s24, s18, 270336
    buffer_load_dwordx4 v4, s[8:11], s24 offen sc1 lds
    s_add_u32 m0, s19, 16384
    s_add_u32 s24, s18, 540672
    buffer_load_dwordx4 v4, s[8:11], s24 offen sc1 lds
    s_add_u32 m0, s19, 24576
    s_add_u32 s24, s18, 811008
    buffer_load_dwordx4 v4, s[8:11], s24 offen sc1 lds
    s_add_u32 m0, s19, 32768
    s_add_u32 s24, s18, 1081344
    buffer_load_dwordx4 v4, s[8:11], s24 offen sc1 lds
    s_add_u32 m0, s19, 40960
    s_add_u32 s24, s18, 1351680
    buffer_load_dwordx4 v4, s[8:11], s24 offen sc1 lds
    s_add_u32 m0, s19, 49152
    s_add_u32 s24, s18, 1622016
    buffer_load_dwordx4 v4, s[8:11], s24 offen sc1 lds
    s_add_u32 m0, s19, 57344
    s_add_u32 s24, s18, 1892352
    buffer_load_dwordx4 v4, s[8:11], s24 offen sc1 lds
    v_bfe_u32 v8, v1, 2, 2
    v_and_b32 v9, 3, v1
    v_lshlrev_b32 v11, 10, v5
    v_lshl_add_u32 v11, v8, 7, v11
    v_lshl_add_u32 v11, v10, 5, v11
    v_lshl_add_u32 v11, v9, 3, v11
    s_lshl_b32 s19, s36, 13
    v_add_u32 v11, s19, v11
    v_lshrrev_b32 v8, 1, v8
    v_lshl_add_u32 v20, v8, 6, v11
    v_xor_b32 v8, 1, v8
    v_lshl_add_u32 v21, v8, 6, v11
    v_mov_b32 v22, 0x3f803f80
    v_lshlrev_b32 v23, 3, v0
    v_add_u32 v23, 0x10000, v23
    v_and_b32 v24, 31, v1
    v_lshlrev_b32 v24, 3, v24
    v_lshl_add_u32 v24, v5, 12, v24
    v_add_u32 v24, 0x10000, v24
    v_lshlrev_b32 v25, 3, v1
    s_waitcnt vmcnt(0)
    s_barrier
    ds_read_b64_tr_b16 v[32:33], v20 offset:0
    ds_read_b64_tr_b16 v[34:35], v20 offset:512
    ds_read_b64_tr_b16 v[36:37], v21 offset:0
    ds_read_b64_tr_b16 v[38:39], v21 offset:512
    ds_read_b64_tr_b16 v[40:41], v20 offset:2048
    ds_read_b64_tr_b16 v[42:43], v20 offset:2560
    ds_read_b64_tr_b16 v[44:45], v21 offset:2048
    ds_read_b64_tr_b16 v[46:47], v21 offset:2560
    s_waitcnt lgkmcnt(0)
    ds_read_b64_tr_b16 v[48:49], v20 offset:4096
    ds_read_b64_tr_b16 v[50:51], v20 offset:4608
    ds_read_b64_tr_b16 v[52:53], v21 offset:4096
    ds_read_b64_tr_b16 v[54:55], v21 offset:4608
    ds_read_b64_tr_b16 v[56:57], v20 offset:6144
    ds_read_b64_tr_b16 v[58:59], v20 offset:6656
    ds_read_b64_tr_b16 v[60:61], v21 offset:6144
    ds_read_b64_tr_b16 v[62:63], v21 offset:6656
    s_waitcnt lgkmcnt(0)
    v_dot2_f32_bf16 v12, v32, v22, 0
    v_dot2_f32_bf16 v13, v32, v32, 0
    v_dot2_f32_bf16 v14, v36, v22, 0
    v_dot2_f32_bf16 v15, v36, v36, 0
    v_dot2_f32_bf16 v12, v33, v22, v12
    v_dot2_f32_bf16 v13, v33, v33, v13
    v_dot2_f32_bf16 v14, v37, v22, v14
    v_dot2_f32_bf16 v15, v37, v37, v15
    v_dot2_f32_bf16 v12, v34, v22, v12
    v_dot2_f32_bf16 v13, v34, v34, v13
    v_dot2_f32_bf16 v14, v38, v22, v14
    v_dot2_f32_bf16 v15, v38, v38, v15
    v_dot2_f32_bf16 v12, v35, v22, v12
    v_dot2_f32_bf16 v13, v35, v35, v13
    v_dot2_f32_bf16 v14, v39, v22, v14
    v_dot2_f32_bf16 v15, v39, v39, v15
    v_dot2_f32_bf16 v12, v40, v22, v12
    v_dot2_f32_bf16 v13, v40, v40, v13
    v_dot2_f32_bf16 v14, v44, v22, v14
    v_dot2_f32_bf16 v15, v44, v44, v15
    v_dot2_f32_bf16 v12, v41, v22, v12
    v_dot2_f32_bf16 v13, v41, v41, v13
    v_dot2_f32_bf16 v14, v45, v22, v14
    v_dot2_f32_bf16 v15, v45, v45, v15
    v_dot2_f32_bf16 v12, v42, v22, v12
    v_dot2_f32_bf16 v13, v42, v42, v13
    v_dot2_f32_bf16 v14, v46, v22, v14
    v_dot2_f32_bf16 v15, v46, v46, v15
    v_dot2_f32_bf16 v12, v43, v22, v12
    v_dot2_f32_bf16 v13, v43, v43, v13
    v_dot2_f32_bf16 v14, v47, v22, v14
    v_dot2_f32_bf16 v15, v47, v47, v15
    v_dot2_f32_bf16 v12, v48, v22, v12
    v_dot2_f32_bf16 v13, v48, v48, v13
    v_dot2_f32_bf16 v14, v52, v22, v14
    v_dot2_f32_bf16 v15, v52, v52, v15
    v_dot2_f32_bf16 v12, v49, v22, v12
    v_dot2_f32_bf16 v13, v49, v49, v13
    v_dot2_f32_bf16 v14, v53, v22, v14
    v_dot2_f32_bf16 v15, v53, v53, v15
    v_dot2_f32_bf16 v12, v50, v22, v12
    v_dot2_f32_bf16 v13, v50, v50, v13
    v_dot2_f32_bf16 v14, v54, v22, v14
    v_dot2_f32_bf16 v15, v54, v54, v15
    v_dot2_f32_bf16 v12, v51, v22, v12
    v_dot2_f32_bf16 v13, v51, v51, v13
    v_dot2_f32_bf16 v14, v55, v22, v14
    v_dot2_f32_bf16 v15, v55, v55, v15
    v_dot2_f32_bf16 v12, v56, v22, v12
    v_dot2_f32_bf16 v13, v56, v56, v13
    v_dot2_f32_bf16 v14, v60, v22, v14
    v_dot2_f32_bf16 v15, v60, v60, v15
    v_dot2_f32_bf16 v12, v57, v22, v12
    v_dot2_f32_bf16 v13, v57, v57, v13
    v_dot2_f32_bf16 v14, v61, v22, v14
    v_dot2_f32_bf16 v15, v61, v61, v15
    v_dot2_f32_bf16 v12, v58, v22, v12
    v_dot2_f32_bf16 v13, v58, v58, v13
    v_dot2_f32_bf16 v14, v62, v22, v14
    v_dot2_f32_bf16 v15, v62, v62, v15
    v_dot2_f32_bf16 v12, v59, v22, v12
    v_dot2_f32_bf16 v13, v59, v59, v13
    v_dot2_f32_bf16 v14, v63, v22, v14
    v_dot2_f32_bf16 v15, v63, v63, v15
    s_nop 2
    ds_write_b64 v23, v[12:13]
    ds_write_b64 v23, v[14:15] offset:4096
    s_waitcnt lgkmcnt(0)
    s_barrier
    s_cmp_lg_u32 s36, 0
    s_cbranch_scc1 Lg1_pf
    ds_read_b64 v[64:65], v24 offset:0
    ds_read_b64 v[66:67], v24 offset:256
    ds_read_b64 v[68:69], v24 offset:512
    ds_read_b64 v[70:71], v24 offset:768
    ds_read_b64 v[72:73], v24 offset:1024
    ds_read_b64 v[74:75], v24 offset:1280
    ds_read_b64 v[76:77], v24 offset:1536
    ds_read_b64 v[78:79], v24 offset:1792
    s_waitcnt lgkmcnt(0)
    ds_read_b64 v[80:81], v24 offset:2048
    ds_read_b64 v[82:83], v24 offset:2304
    ds_read_b64 v[84:85], v24 offset:2560
    ds_read_b64 v[86:87], v24 offset:2816
    ds_read_b64 v[88:89], v24 offset:3072
    ds_read_b64 v[90:91], v24 offset:3328
    ds_read_b64 v[92:93], v24 offset:3584
    ds_read_b64 v[94:95], v24 offset:3840
    s_waitcnt lgkmcnt(0)
    v_pk_add_f32 v[64:65], v[64:65], v[66:67]
    v_pk_add_f32 v[68:69], v[68:69], v[70:71]
    v_pk_add_f32 v[72:73], v[72:73], v[74:75]
    v_pk_add_f32 v[76:77], v[76:77], v[78:79]
    v_pk_add_f32 v[80:81], v[80:81], v[82:83]
    v_pk_add_f32 v[84:85], v[84:85], v[86:87]
    v_pk_add_f32 v[88:89], v[88:89], v[90:91]
    v_pk_add_f32 v[92:93], v[92:93], v[94:95]
    v_pk_add_f32 v[64:65], v[64:65], v[68:69]
    v_pk_add_f32 v[72:73], v[72:73], v[76:77]
    v_pk_add_f32 v[80:81], v[80:81], v[84:85]
    v_pk_add_f32 v[88:89], v[88:89], v[92:93]
    v_pk_add_f32 v[64:65], v[64:65], v[72:73]
    v_pk_add_f32 v[80:81], v[80:81], v[88:89]
    v_pk_add_f32 v[64:65], v[64:65], v[80:81]
    v_mul_f32 v64, s28, v64
    v_mul_f32 v65, s28, v65
    v_fma_f32 v65, -v64, v64, v65
    v_max_f32 v65, 0, v65
    v_cvt_pk_bf16_f32 v68, v65, v65
    v_and_b32 v68, 0xffff0000, v68
    v_add_f32 v68, s29, v68
    v_cvt_pk_bf16_f32 v68, v68, v68
    v_and_b32 v68, 0xffff0000, v68
    v_sqrt_f32 v68, v68
    s_nop 0
    v_cvt_pk_bf16_f32 v68, v68, v68
    v_and_b32 v68, 0xffff0000, v68
    v_rcp_f32 v71, v68
    s_nop 0
    v_mul_f32 v72, v65, v71
    v_mul_f32 v72, v72, v71
    v_cvt_pk_bf16_f32 v72, v72, v72
    v_and_b32 v72, 0xffff0000, v72
    v_add_f32 v72, s29, v72
    v_cvt_pk_bf16_f32 v72, v72, v72
    v_and_b32 v72, 0xffff0000, v72
    v_sqrt_f32 v72, v72
    s_nop 0
    v_cvt_pk_bf16_f32 v72, v72, v72
    v_and_b32 v72, 0xffff0000, v72
    v_rcp_f32 v72, v72
    s_nop 0
    v_mul_f32 v16, v71, v72
    v_mul_f32 v17, v16, v64
    s_lshl_b32 s19, s14, 9
    s_add_u32 s19, s19, s46
    buffer_store_dwordx2 v[16:17], v25, s[8:11], s19 offen sc1
Lg1_pf:
    s_branch Lg2_start
Lg1_fin:
    s_waitcnt vmcnt(0)
    s_barrier
    s_cmp_lg_u32 s36, 4
    s_cbranch_scc1 Lg2_start
    s_mul_i32 s12, s14, 14
    s_add_u32 s12, s12, s15
    s_lshl_b32 s12, s12, 7
    s_add_u32 s12, s12, s52
    v_mov_b32 v4, 0
    v_mov_b32 v5, 1
    s_mov_b64 exec, 1
    buffer_store_dword v5, v4, s[8:11], s12 offen sc1
    s_mov_b64 exec, -1
Lg2_start:
    s_mov_b32 s20, s72
    s_mov_b32 s21, s73
    s_mov_b32 s22, 0x400
    s_mov_b32 s23, 0x00020000
    s_mov_b32 s44, s74
    s_mov_b32 s45, s75
    s_mov_b32 s46, 0x200000
    s_mov_b32 s47, 0x00020000
    v_lshrrev_b32 v6, 5, v1
    v_and_b32 v7, 31, v1
    s_mul_i32 s12, s77, 114688
    s_add_u32 s12, s12, s78
    s_add_u32 s12, s12, s33
    s_xor_b32 s13, s77, 1
    s_mul_i32 s13, s13, 114688
    s_add_u32 s13, s13, s78
    s_add_u32 s13, s13, s33
    v_add_u32 v4, s12, v3
    v_add_u32 v5, s13, v3
    s_lshl_b32 s16, s76, 5
    s_add_u32 s16, s16, s83
    s_lshl_b32 s17, s16, 1
    v_lshlrev_b32 v8, 3, v6
    v_lshrrev_b32 v9, 2, v1
    v_mul_u32_u24 v9, 4224, v9
    v_and_b32 v10, 3, v1
    v_lshl_add_u32 v9, v10, 4, v9
    s_mul_i32 s18, s16, 4224
    s_lshl_b32 s19, s77, 6
    s_add_u32 s18, s18, s19
    s_add_u32 s19, s18, s32
    s_lshl_b32 s24, s36, 10
    s_add_u32 s24, s24, 114688
    v_lshlrev_b32 v10, 8, v6
    v_lshl_add_u32 v10, v7, 1, v10
    v_add_u32 v10, s24, v10
    v_add_u32 v11, s24, v3
    s_mov_b32 m0, s24
    buffer_load_dwordx2 a[112:113], v8, s[20:23], s17 offen
    buffer_load_dwordx2 a[114:115], v8, s[20:23], s17 offen offset:16
    buffer_load_dwordx4 v9, s[8:11], s19 offen sc1 lds
    s_cmp_lg_u32 s36, 4
    s_cbranch_scc1 Lg2_go
    s_lshr_b32 s25, s54, 1
    s_mul_i32 s25, s25, 1792
    s_add_u32 s25, s25, s52
    v_lshlrev_b32 v12, 7, v1
    s_mov_b32 s26, 0
    s_mov_b64 exec, 0x3fff
Lg2_poll:
    buffer_load_dword v13, v12, s[8:11], s25 offen sc1
    s_waitcnt vmcnt(0)
    v_cmp_eq_u32 vcc, 0, v13
    s_cmp_eq_u64 vcc, 0
    s_cbranch_scc1 Lg2_polled
    s_sleep 2
    s_add_u32 s26, s26, 1
    s_cmp_lt_u32 s26, 40000
    s_cbranch_scc1 Lg2_poll
Lg2_polled:
    s_mov_b64 exec, -1
Lg2_go:
    s_barrier
    s_mov_b32 s84, s79
    buffer_load_dwordx4 v[16:19], v4, s[8:11], s84 offen sc1
    buffer_load_dwordx4 v[20:23], v5, s[8:11], s84 offen sc1
    s_add_u32 s84, s84, 1024
    s_cmp_eq_u32 s84, 14336
    s_cselect_b32 s84, 0, s84
    buffer_load_dwordx4 v[24:27], v4, s[8:11], s84 offen sc1
    buffer_load_dwordx4 v[28:31], v5, s[8:11], s84 offen sc1
    s_add_u32 s84, s84, 1024
    s_cmp_eq_u32 s84, 14336
    s_cselect_b32 s84, 0, s84
    buffer_load_dwordx4 v[32:35], v4, s[8:11], s84 offen sc1
    buffer_load_dwordx4 v[36:39], v5, s[8:11], s84 offen sc1
    s_add_u32 s84, s84, 1024
    s_cmp_eq_u32 s84, 14336
    s_cselect_b32 s84, 0, s84
    buffer_load_dwordx4 v[40:43], v4, s[8:11], s84 offen sc1
    buffer_load_dwordx4 v[44:47], v5, s[8:11], s84 offen sc1
    s_add_u32 s84, s84, 1024
    s_cmp_eq_u32 s84, 14336
    s_cselect_b32 s84, 0, s84
    buffer_load_dwordx4 v[48:51], v4, s[8:11], s84 offen sc1
    buffer_load_dwordx4 v[52:55], v5, s[8:11], s84 offen sc1
    s_add_u32 s84, s84, 1024
    s_cmp_eq_u32 s84, 14336
    s_cselect_b32 s84, 0, s84
    buffer_load_dwordx4 v[56:59], v4, s[8:11], s84 offen sc1
    buffer_load_dwordx4 v[60:63], v5, s[8:11], s84 offen sc1
    s_add_u32 s84, s84, 1024
    s_cmp_eq_u32 s84, 14336
    s_cselect_b32 s84, 0, s84
    s_waitcnt vmcnt(10)
    v_mfma_f32_32x32x16_bf16 v[64:79], a[0:3], v[16:19], 0
    v_mfma_f32_32x32x16_bf16 v[80:95], a[0:3], v[20:23], 0
    v_mfma_f32_32x32x16_bf16 v[96:111], a[4:7], v[16:19], 0
    v_mfma_f32_32x32x16_bf16 v[112:127], a[4:7], v[20:23], 0
    buffer_load_dwordx4 v[16:19], v4, s[8:11], s84 offen sc1
    buffer_load_dwordx4 v[20:23], v5, s[8:11], s84 offen sc1
    s_add_u32 s84, s84, 1024
    s_cmp_eq_u32 s84, 14336
    s_cselect_b32 s84, 0, s84
    s_waitcnt vmcnt(10)
    v_mfma_f32_32x32x16_bf16 v[64:79], a[8:11], v[24:27], v[64:79]
    v_mfma_f32_32x32x16_bf16 v[80:95], a[8:11], v[28:31], v[80:95]
    v_mfma_f32_32x32x16_bf16 v[96:111], a[12:15], v[24:27], v[96:111]
    v_mfma_f32_32x32x16_bf16 v[112:127], a[12:15], v[28:31], v[112:127]
    buffer_load_dwordx4 v[24:27], v4, s[8:11], s84 offen sc1
    buffer_load_dwordx4 v[28:31], v5, s[8:11], s84 offen sc1
    s_add_u32 s84, s84, 1024
    s_cmp_eq_u32 s84, 14336
    s_cselect_b32 s84, 0, s84
    s_waitcnt vmcnt(10)
    v_mfma_f32_32x32x16_bf16 v[64:79], a[16:19], v[32:35], v[64:79]
    v_mfma_f32_32x32x16_bf16 v[80:95], a[16:19], v[36:39], v[80:95]
    v_mfma_f32_32x32x16_bf16 v[96:111], a[20:23], v[32:35], v[96:111]
    v_mfma_f32_32x32x16_bf16 v[112:127], a[20:23], v[36:39], v[112:127]
    buffer_load_dwordx4 v[32:35], v4, s[8:11], s84 offen sc1
    buffer_load_dwordx4 v[36:39], v5, s[8:11], s84 offen sc1
    s_add_u32 s84, s84, 1024
    s_cmp_eq_u32 s84, 14336
    s_cselect_b32 s84, 0, s84
    s_waitcnt vmcnt(10)
    v_mfma_f32_32x32x16_bf16 v[64:79], a[24:27], v[40:43], v[64:79]
    v_mfma_f32_32x32x16_bf16 v[80:95], a[24:27], v[44:47], v[80:95]
    v_mfma_f32_32x32x16_bf16 v[96:111], a[28:31], v[40:43], v[96:111]
    v_mfma_f32_32x32x16_bf16 v[112:127], a[28:31], v[44:47], v[112:127]
    buffer_load_dwordx4 v[40:43], v4, s[8:11], s84 offen sc1
    buffer_load_dwordx4 v[44:47], v5, s[8:11], s84 offen sc1
    s_add_u32 s84, s84, 1024
    s_cmp_eq_u32 s84, 14336
    s_cselect_b32 s84, 0, s84
    s_waitcnt vmcnt(10)
    v_mfma_f32_32x32x16_bf16 v[64:79], a[32:35], v[48:51], v[64:79]
    v_mfma_f32_32x32x16_bf16 v[80:95], a[32:35], v[52:55], v[80:95]
    v_mfma_f32_32x32x16_bf16 v[96:111], a[36:39], v[48:51], v[96:111]
    v_mfma_f32_32x32x16_bf16 v[112:127], a[36:39], v[52:55], v[112:127]
    buffer_load_dwordx4 v[48:51], v4, s[8:11], s84 offen sc1
    buffer_load_dwordx4 v[52:55], v5, s[8:11], s84 offen sc1
    s_add_u32 s84, s84, 1024
    s_cmp_eq_u32 s84, 14336
    s_cselect_b32 s84, 0, s84
    s_waitcnt vmcnt(10)
    v_mfma_f32_32x32x16_bf16 v[64:79], a[40:43], v[56:59], v[64:79]
    v_mfma_f32_32x32x16_bf16 v[80:95], a[40:43], v[60:63], v[80:95]
    v_mfma_f32_32x32x16_bf16 v[96:111], a[44:47], v[56:59], v[96:111]
    v_mfma_f32_32x32x16_bf16 v[112:127], a[44:47], v[60:63], v[112:127]
    buffer_load_dwordx4 v[56:59], v4, s[8:11], s84 offen sc1
    buffer_load_dwordx4 v[60:63], v5, s[8:11], s84 offen sc1
    s_add_u32 s84, s84, 1024
    s_cmp_eq_u32 s84, 14336
    s_cselect_b32 s84, 0, s84
    s_waitcnt vmcnt(10)
    v_mfma_f32_32x32x16_bf16 v[64:79], a[48:51], v[16:19], v[64:79]
    v_mfma_f32_32x32x16_bf16 v[80:95], a[48:51], v[20:23], v[80:95]
    v_mfma_f32_32x32x16_bf16 v[96:111], a[52:55], v[16:19], v[96:111]
    v_mfma_f32_32x32x16_bf16 v[112:127], a[52:55], v[20:23], v[112:127]
    buffer_load_dwordx4 v[16:19], v4, s[8:11], s84 offen sc1
    buffer_load_dwordx4 v[20:23], v5, s[8:11], s84 offen sc1
    s_add_u32 s84, s84, 1024
    s_cmp_eq_u32 s84, 14336
    s_cselect_b32 s84, 0, s84
    s_waitcnt vmcnt(10)
    v_mfma_f32_32x32x16_bf16 v[64:79], a[56:59], v[24:27], v[64:79]
    v_mfma_f32_32x32x16_bf16 v[80:95], a[56:59], v[28:31], v[80:95]
    v_mfma_f32_32x32x16_bf16 v[96:111], a[60:63], v[24:27], v[96:111]
    v_mfma_f32_32x32x16_bf16 v[112:127], a[60:63], v[28:31], v[112:127]
    buffer_load_dwordx4 v[24:27], v4, s[8:11], s84 offen sc1
    buffer_load_dwordx4 v[28:31], v5, s[8:11], s84 offen sc1
    s_add_u32 s84, s84, 1024
    s_cmp_eq_u32 s84, 14336
    s_cselect_b32 s84, 0, s84
    s_waitcnt vmcnt(10)
    v_mfma_f32_32x32x16_bf16 v[64:79], a[64:67], v[32:35], v[64:79]
    v_mfma_f32_32x32x16_bf16 v[80:95], a[64:67], v[36:39], v[80:95]
    v_mfma_f32_32x32x16_bf16 v[96:111], a[68:71], v[32:35], v[96:111]
    v_mfma_f32_32x32x16_bf16 v[112:127], a[68:71], v[36:39], v[112:127]
    s_waitcnt vmcnt(8)
    v_mfma_f32_32x32x16_bf16 v[64:79], a[72:75], v[40:43], v[64:79]
    v_mfma_f32_32x32x16_bf16 v[80:95], a[72:75], v[44:47], v[80:95]
    v_mfma_f32_32x32x16_bf16 v[96:111], a[76:79], v[40:43], v[96:111]
    v_mfma_f32_32x32x16_bf16 v[112:127], a[76:79], v[44:47], v[112:127]
    s_waitcnt vmcnt(6)
    v_mfma_f32_32x32x16_bf16 v[64:79], a[80:83], v[48:51], v[64:79]
    v_mfma_f32_32x32x16_bf16 v[80:95], a[80:83], v[52:55], v[80:95]
    v_mfma_f32_32x32x16_bf16 v[96:111], a[84:87], v[48:51], v[96:111]
    v_mfma_f32_32x32x16_bf16 v[112:127], a[84:87], v[52:55], v[112:127]
    s_waitcnt vmcnt(4)
    v_mfma_f32_32x32x16_bf16 v[64:79], a[88:91], v[56:59], v[64:79]
    v_mfma_f32_32x32x16_bf16 v[80:95], a[88:91], v[60:63], v[80:95]
    v_mfma_f32_32x32x16_bf16 v[96:111], a[92:95], v[56:59], v[96:111]
    v_mfma_f32_32x32x16_bf16 v[112:127], a[92:95], v[60:63], v[112:127]
    s_waitcnt vmcnt(2)
    v_mfma_f32_32x32x16_bf16 v[64:79], a[96:99], v[16:19], v[64:79]
    v_mfma_f32_32x32x16_bf16 v[80:95], a[96:99], v[20:23], v[80:95]
    v_mfma_f32_32x32x16_bf16 v[96:111], a[100:103], v[16:19], v[96:111]
    v_mfma_f32_32x32x16_bf16 v[112:127], a[100:103], v[20:23], v[112:127]
    s_xor_b32 s27, s36, 1
    s_mul_i32 s27, s27, 14336
    s_add_u32 s27, s27, 0
    v_add_u32 v16, s27, v3
    s_xor_b32 s27, s36, 2
    s_mul_i32 s27, s27, 14336
    s_add_u32 s27, s27, 2048
    v_add_u32 v17, s27, v3
    s_xor_b32 s27, s36, 3
    s_mul_i32 s27, s27, 14336
    s_add_u32 s27, s27, 4096
    v_add_u32 v18, s27, v3
    s_xor_b32 s27, s36, 4
    s_mul_i32 s27, s27, 14336
    s_add_u32 s27, s27, 6144
    v_add_u32 v19, s27, v3
    s_xor_b32 s27, s36, 5
    s_mul_i32 s27, s27, 14336
    s_add_u32 s27, s27, 8192
    v_add_u32 v20, s27, v3
    s_xor_b32 s27, s36, 6
    s_mul_i32 s27, s27, 14336
    s_add_u32 s27, s27, 10240
    v_add_u32 v21, s27, v3
    s_xor_b32 s27, s36, 7
    s_mul_i32 s27, s27, 14336
    s_add_u32 s27, s27, 12288
    v_add_u32 v22, s27, v3
    s_mul_i32 s27, s36, 14336
    v_add_u32 v15, s27, v3
    s_waitcnt vmcnt(0)
    v_mfma_f32_32x32x16_bf16 v[80:95], a[104:107], v[28:31], v[80:95]
    v_mfma_f32_32x32x16_bf16 v[96:111], a[108:111], v[24:27], v[96:111]
    v_mfma_f32_32x32x16_bf16 v[112:127], a[108:111], v[28:31], v[112:127]
    v_mfma_f32_32x32x16_bf16 v[64:79], a[104:107], v[24:27], v[64:79]
    ds_read_u16_d16_hi v24, v10 offset:0
    ds_read_u16_d16_hi v25, v10 offset:64
    ds_read_u16_d16_hi v26, v10 offset:128
    ds_read_u16_d16_hi v27, v10 offset:192
    ds_read_u16_d16_hi v28, v10 offset:512
    ds_read_u16_d16_hi v29, v10 offset:576
    ds_read_u16_d16_hi v30, v10 offset:640
    ds_read_u16_d16_hi v31, v10 offset:704
    s_nop 1
    ds_write_b128 v16, v[80:83] offset:0
    ds_write_b128 v16, v[84:87] offset:1024
    ds_write_b128 v20, v[88:91] offset:0
    ds_write_b128 v20, v[92:95] offset:1024
    ds_write_b128 v17, v[96:99] offset:0
    ds_write_b128 v17, v[100:103] offset:1024
    s_waitcnt lgkmcnt(6)
    ds_write_b128 v21, v[104:107] offset:0
    ds_write_b128 v21, v[108:111] offset:1024
    ds_write_b128 v18, v[112:115] offset:0
    ds_write_b128 v18, v[116:119] offset:1024
    ds_write_b128 v22, v[120:123] offset:0
    ds_write_b128 v22, v[124:127] offset:1024
    ds_write_b128 v19, v[72:75] offset:0
    ds_write_b128 v19, v[76:79] offset:1024
    v_and_b32 v24, 0xffff0000, v24
    v_and_b32 v25, 0xffff0000, v25
    v_and_b32 v26, 0xffff0000, v26
    v_and_b32 v27, 0xffff0000, v27
    v_and_b32 v28, 0xffff0000, v28
    v_and_b32 v29, 0xffff0000, v29
    v_and_b32 v30, 0xffff0000, v30
    v_and_b32 v31, 0xffff0000, v31
    v_accvgpr_read_b32 v40, a112
    v_accvgpr_read_b32 v41, a113
    v_accvgpr_read_b32 v42, a114
    v_accvgpr_read_b32 v43, a115
    v_lshlrev_b32 v32, 16, v40
    v_and_b32 v33, 0xffff0000, v40
    v_lshlrev_b32 v34, 16, v41
    v_and_b32 v35, 0xffff0000, v41
    v_lshlrev_b32 v36, 16, v42
    v_and_b32 v37, 0xffff0000, v42
    v_lshlrev_b32 v38, 16, v43
    v_and_b32 v39, 0xffff0000, v43
    s_waitcnt lgkmcnt(0)
    s_barrier
    ds_read_b128 v[72:75], v15 offset:0
    ds_read_b128 v[80:83], v15 offset:2048
    ds_read_b128 v[88:91], v15 offset:4096
    ds_read_b128 v[96:99], v15 offset:6144
    ds_read_b128 v[104:107], v15 offset:8192
    ds_read_b128 v[112:115], v15 offset:10240
    ds_read_b128 v[120:123], v15 offset:12288
    ds_read_b128 v[76:79], v15 offset:1024
    ds_read_b128 v[84:87], v15 offset:3072
    ds_read_b128 v[92:95], v15 offset:5120
    ds_read_b128 v[100:103], v15 offset:7168
    ds_read_b128 v[108:111], v15 offset:9216
    ds_read_b128 v[116:119], v15 offset:11264
    ds_read_b128 v[124:127], v15 offset:13312
    s_waitcnt lgkmcnt(7)
    v_pk_add_f32 v[64:65], v[64:65], v[72:73]
    v_pk_add_f32 v[66:67], v[66:67], v[74:75]
    v_pk_add_f32 v[80:81], v[80:81], v[88:89]
    v_pk_add_f32 v[82:83], v[82:83], v[90:91]
    v_pk_add_f32 v[96:97], v[96:97], v[104:105]
    v_pk_add_f32 v[98:99], v[98:99], v[106:107]
    v_pk_add_f32 v[112:113], v[112:113], v[120:121]
    v_pk_add_f32 v[114:115], v[114:115], v[122:123]
    v_pk_add_f32 v[64:65], v[64:65], v[80:81]
    v_pk_add_f32 v[66:67], v[66:67], v[82:83]
    v_pk_add_f32 v[96:97], v[96:97], v[112:113]
    v_pk_add_f32 v[98:99], v[98:99], v[114:115]
    v_pk_add_f32 v[64:65], v[64:65], v[96:97]
    v_pk_add_f32 v[66:67], v[66:67], v[98:99]
    v_cvt_pk_bf16_f32 v12, v64, v65
    v_cvt_pk_bf16_f32 v13, v66, v67
    v_lshlrev_b32 v64, 16, v12
    v_and_b32 v65, 0xffff0000, v12
    v_lshlrev_b32 v66, 16, v13
    v_and_b32 v67, 0xffff0000, v13
    v_pk_add_f32 v[64:65], v[64:65], v[32:33]
    v_pk_add_f32 v[66:67], v[66:67], v[34:35]
    v_cvt_pk_bf16_f32 v12, v64, v65
    v_cvt_pk_bf16_f32 v13, v66, v67
    v_lshlrev_b32 v64, 16, v12
    v_and_b32 v65, 0xffff0000, v12
    v_lshlrev_b32 v66, 16, v13
    v_and_b32 v67, 0xffff0000, v13
    v_pk_add_f32 v[64:65], v[64:65], v[24:25]
    v_pk_add_f32 v[66:67], v[66:67], v[26:27]
    v_cvt_pk_bf16_f32 v44, v64, v65
    v_cvt_pk_bf16_f32 v45, v66, v67
    s_waitcnt lgkmcnt(0)
    v_pk_add_f32 v[68:69], v[68:69], v[76:77]
    v_pk_add_f32 v[70:71], v[70:71], v[78:79]
    v_pk_add_f32 v[84:85], v[84:85], v[92:93]
    v_pk_add_f32 v[86:87], v[86:87], v[94:95]
    v_pk_add_f32 v[100:101], v[100:101], v[108:109]
    v_pk_add_f32 v[102:103], v[102:103], v[110:111]
    v_pk_add_f32 v[116:117], v[116:117], v[124:125]
    v_pk_add_f32 v[118:119], v[118:119], v[126:127]
    v_pk_add_f32 v[68:69], v[68:69], v[84:85]
    v_pk_add_f32 v[70:71], v[70:71], v[86:87]
    v_pk_add_f32 v[100:101], v[100:101], v[116:117]
    v_pk_add_f32 v[102:103], v[102:103], v[118:119]
    v_pk_add_f32 v[68:69], v[68:69], v[100:101]
    v_pk_add_f32 v[70:71], v[70:71], v[102:103]
    v_cvt_pk_bf16_f32 v12, v68, v69
    v_cvt_pk_bf16_f32 v13, v70, v71
    v_lshlrev_b32 v68, 16, v12
    v_and_b32 v69, 0xffff0000, v12
    v_lshlrev_b32 v70, 16, v13
    v_and_b32 v71, 0xffff0000, v13
    v_pk_add_f32 v[68:69], v[68:69], v[36:37]
    v_pk_add_f32 v[70:71], v[70:71], v[38:39]
    v_cvt_pk_bf16_f32 v12, v68, v69
    v_cvt_pk_bf16_f32 v13, v70, v71
    v_lshlrev_b32 v68, 16, v12
    v_and_b32 v69, 0xffff0000, v12
    v_lshlrev_b32 v70, 16, v13
    v_and_b32 v71, 0xffff0000, v13
    v_pk_add_f32 v[68:69], v[68:69], v[28:29]
    v_pk_add_f32 v[70:71], v[70:71], v[30:31]
    v_cvt_pk_bf16_f32 v46, v68, v69
    v_cvt_pk_bf16_f32 v47, v70, v71
    s_cmp_eq_u32 s53, 0
    s_cbranch_scc0 Lg2_final
    ds_write_b16 v10, v44 offset:0
    ds_write_b16_d16_hi v10, v44 offset:64
    ds_write_b16 v10, v45 offset:128
    ds_write_b16_d16_hi v10, v45 offset:192
    ds_write_b16 v10, v46 offset:512
    ds_write_b16_d16_hi v10, v46 offset:576
    ds_write_b16 v10, v47 offset:640
    ds_write_b16_d16_hi v10, v47 offset:704
    v_mov_b32 v12, 0
    v_mov_b32 v13, 0
    v_mov_b32 v14, 0x3f803f80
    v_dot2_f32_bf16 v12, v44, v14, v12
    v_dot2_f32_bf16 v13, v44, v44, v13
    v_dot2_f32_bf16 v12, v45, v14, v12
    v_dot2_f32_bf16 v13, v45, v45, v13
    v_dot2_f32_bf16 v12, v46, v14, v12
    v_dot2_f32_bf16 v13, v46, v46, v13
    v_dot2_f32_bf16 v12, v47, v14, v12
    v_dot2_f32_bf16 v13, v47, v47, v13
    s_waitcnt lgkmcnt(0)
    ds_read_b128 v[64:67], v11
    v_lshlrev_b32 v16, 3, v7
    v_lshl_add_u32 v16, v6, 2, v16
    s_lshl_b32 s27, s77, 8
    s_add_u32 s27, s27, 33619968
    v_permlane32_swap_b32 v12, v13
    s_add_u32 s19, s18, 46137344
    s_nop 0
    v_add_f32 v12, v12, v13
    buffer_atomic_add_f32 v12, v16, s[8:11], s27 offen
    s_waitcnt lgkmcnt(0)
    buffer_store_dwordx4 v[64:67], v9, s[8:11], s19 offen sc1
    s_branch Lg2_fin
Lg2_final:
    v_lshlrev_b32 v16, 10, v7
    v_lshl_add_u32 v16, v6, 4, v16
    s_lshl_b32 s27, s77, 15
    s_add_u32 s27, s27, s17
    v_permlane32_swap_b32 v44, v46
    v_permlane32_swap_b32 v45, v47
    buffer_store_dwordx4 v[44:47], v16, s[44:47], s27 offen
Lg2_fin:
Lg1_end:
    s_endpgm
Ltext_end:
.section .rodata,"a"
.p2align 6
.amdhsa_kernel prep_kernel
  .amdhsa_next_free_vgpr 128
  .amdhsa_next_free_sgpr 96
  .amdhsa_accum_offset 128
  .amdhsa_group_segment_fixed_size 0
  .amdhsa_kernarg_size 120
  .amdhsa_user_sgpr_count 2
  .amdhsa_user_sgpr_kernarg_segment_ptr 1
  .amdhsa_system_sgpr_workgroup_id_x 1
.end_amdhsa_kernel
.p2align 6
.amdhsa_kernel cm1_kernel
  .amdhsa_next_free_vgpr 256
  .amdhsa_next_free_sgpr 102
  .amdhsa_accum_offset 128
  .amdhsa_group_segment_fixed_size 0
  .amdhsa_kernarg_size 120
  .amdhsa_user_sgpr_count 2
  .amdhsa_user_sgpr_kernarg_segment_ptr 1
  .amdhsa_system_sgpr_workgroup_id_x 1
.end_amdhsa_kernel
.p2align 6
.amdhsa_kernel cm2_kernel
  .amdhsa_next_free_vgpr 256
  .amdhsa_next_free_sgpr 102
  .amdhsa_accum_offset 128
  .amdhsa_group_segment_fixed_size 0
  .amdhsa_kernarg_size 120
  .amdhsa_user_sgpr_count 2
  .amdhsa_user_sgpr_kernarg_segment_ptr 1
  .amdhsa_system_sgpr_workgroup_id_x 1
.end_amdhsa_kernel
```
